```python
import torch

def _softmax(x, axis=-1):
    return torch.softmax(x, dim=axis)

def _gelu(x):
    return torch.nn.functional.gelu(x, approximate='tanh')

def _silu(x):
    return torch.nn.functional.silu(x)

def _sigmoid(x):
    return torch.sigmoid(x)

def _layernorm(x, axis=-1, eps=1e-05):
    m = x.mean(dim=axis, keepdim=True)
    v = x.var(dim=axis, keepdim=True, unbiased=False)
    return (x - m) / torch.sqrt(v + eps)

def _scatter_add(tgt, idx, src, axis=0):
    return tgt.clone().index_add_(axis, idx, src)

def _segment_sum(src, seg, n):
    out = torch.zeros((n,) + src.shape[1:], dtype=src.dtype)
    return out.index_add_(0, seg, src)

def _pad(x, pw):
    flat = tuple((v for pair in reversed(pw) for v in pair))
    return torch.nn.functional.pad(x, flat)
kernel_name = 'adaLN_cond__spectral_gfnet__glu_gated_bilinear__prompt'

def setup_inputs():

    _w = lambda a: (lambda t: t.to(torch.bfloat16) if t.is_floating_point() else t)(torch.as_tensor(a))

    def _A_setup():
        B, S, D = (1, 2048, 512)
        Df = D // 2 + 1
        return {'x': _w((lambda *s: torch.randn(*s, dtype=torch.bfloat16) * 0.05)(B, S, D)), 'w_r': _w((lambda *s: torch.randn(*s, dtype=torch.bfloat16) * 1.6)(S, Df) * 0.02), 'w_i': _w((lambda *s: torch.randn(*s, dtype=torch.bfloat16) * 1.6)(S, Df) * 0.02)}
    _A_in = _A_setup()

    def _B_setup():
        B, S, D, F = (1, 2048, 512, 1792)
        return {'x': _w((lambda *s: torch.randn(*s, dtype=torch.bfloat16) * 0.05)(B, S, D)), 'w_gate': _w((lambda *s: torch.randn(*s, dtype=torch.bfloat16) * 0.4)(D, F) * D ** (-0.5)), 'w_up': _w((lambda *s: torch.randn(*s, dtype=torch.bfloat16) * 0.4)(D, F) * D ** (-0.5)), 'w_down': _w((lambda *s: torch.randn(*s, dtype=torch.bfloat16) * 0.4)(F, D) * F ** (-0.5))}
    _B_in = _B_setup()
    return {'A_x': _A_in['x'], 'A_w_r': _A_in['w_r'], 'A_w_i': _A_in['w_i'], 'B_x': _B_in['x'], 'B_w_gate': _B_in['w_gate'], 'B_w_up': _B_in['w_up'], 'B_w_down': _B_in['w_down'], 'c': _w((lambda *s: torch.randn(*s, dtype=torch.bfloat16) * 0.2)(1, 512) * 8.0), 'w_mod': _w((lambda *s: torch.randn(*s, dtype=torch.bfloat16) * 0.2)(512, 6 * 512) * 512 ** (-0.5) * 8.0)}

def reference(A_x, A_w_r, A_w_i, B_x, B_w_gate, B_w_up, B_w_down, c, w_mod):

    def _A_ref(x, w_r, w_i):
        B, S, D = x.shape
        X = (lambda x, axes=(-2, -1): torch.fft.rfft2(x.float(), dim=axes))(x, axes=(-2, -1))
        W = w_r + 1j * w_i
        X = X * W
        y = (lambda x, s, axes=(-2, -1): torch.fft.irfft2(x, s=s, dim=axes).to(torch.bfloat16))(X, (S, D), axes=(-2, -1))
        return y

    def _B_ref(x, w_gate, w_up, w_down):
        g = torch.einsum('bsd,df->bsf', x, w_gate)
        u = torch.einsum('bsd,df->bsf', x, w_up)
        h = g * u
        return torch.einsum('bsf,fd->bsd', h, w_down)
    x = A_x
    mod = (_silu(c) @ w_mod).reshape(c.shape[0], 6, 1, -1)
    sa, ca, ga, sb, cb, gb = (mod[:, 0].clone(), mod[:, 1].clone(), mod[:, 2].clone(), mod[:, 3].clone(), mod[:, 4].clone(), mod[:, 5].clone())
    h = _layernorm(x, axis=-1) * (1 + ca) + sa
    x = x + ga * _A_ref(h, A_w_r, A_w_i)
    h = _layernorm(x, axis=-1) * (1 + cb) + sb
    x = x + gb * _B_ref(h, B_w_gate, B_w_up, B_w_down)
    return x
```

```asm
; @launch kernel=adaLN_cond__spectral_gfnet__glu_gated_bilinear__prompt_kernel grid=(256,1,1) block=(256,1,1) lds=152832
.amdgcn_target "amdgcn-amd-amdhsa--gfx950"
.text
.globl adaLN_cond__spectral_gfnet__glu_gated_bilinear__prompt_kernel
.p2align 8
.type adaLN_cond__spectral_gfnet__glu_gated_bilinear__prompt_kernel,@function
adaLN_cond__spectral_gfnet__glu_gated_bilinear__prompt_kernel:
    s_cmp_ge_u32 s2, 256
    s_cbranch_scc1 adaLN_cond__spectral_gfnet__glu_gated_bilinear__prompt_kernel_END1
    s_load_dwordx16 s[4:19], s[0:1], 0
    s_load_dwordx8 s[20:27], s[0:1], 64
    v_lshrrev_b32 v2, 6, v0
    v_and_b32 v1, 63, v0
    v_readfirstlane_b32 s3, v2
    v_and_b32 v24, 15, v0
    v_bfe_u32 v25, v0, 4, 2
    v_lshlrev_b32 v3, 4, v1
    s_and_b32 s28, s2, 7
    s_lshr_b32 s29, s2, 3
    s_and_b32 s30, s28, 1
    s_lshl_b32 s30, s30, 3
    s_lshr_b32 s31, s28, 1
    s_lshl_b32 s31, s31, 2
    s_and_b32 s28, s29, 7
    s_add_u32 s30, s30, s28
    s_lshr_b32 s28, s29, 3
    s_add_u32 s31, s31, s28
    s_lshl_b32 s32, s30, 4
    s_add_u32 s32, s32, s31
    s_bfe_u32 s28, s32, 0x20005
    s_lshl_b32 s33, s28, 9
    s_bfe_u32 s28, s32, 0x20003
    s_lshl_b32 s28, s28, 7
    s_add_u32 s33, s33, s28
    s_and_b32 s28, s3, 3
    s_lshl_b32 s28, s28, 5
    s_add_u32 s33, s33, s28
    s_lshr_b32 s28, s32, 7
    s_lshl_b32 s28, s28, 4
    s_add_u32 s33, s33, s28
    s_and_b32 s28, s32, 7
    s_lshl_b32 s28, s28, 1
    s_add_u32 s33, s33, s28
    s_lshr_b32 s28, s3, 2
    s_add_u32 s33, s33, s28
    s_lshl_b32 s33, s33, 10
    v_mov_b32 v4, 0
    s_and_b32 s42, s2, 15
    s_lshr_b32 s43, s2, 4
    s_lshl_b32 s43, s43, 7
    s_lshl_b32 s41, s2, 8
    s_sub_u32 s28, s2, 192
    s_and_b32 s29, s28, 31
    s_add_u32 s29, s29, 16
    s_lshr_b32 s44, s28, 5
    s_lshl_b32 s44, s44, 8
    s_lshl_b32 s28, s28, 8
    s_add_u32 s28, s28, 0x4000
    s_cmp_lt_u32 s2, 64
    s_cselect_b32 s42, s42, s29
    s_cselect_b32 s43, s43, s44
    s_cselect_b32 s41, s41, s28
    s_add_u32 s41, s41, 0x214000
    s_lshl_b32 s28, s3, 3
    s_add_u32 s43, s43, s28
    s_lshl_b32 s40, s43, 1
    s_mul_i32 s35, s43, 6144
    s_lshl_b32 s28, s42, 7
    s_add_u32 s35, s35, s28
    v_lshrrev_b32 v2, 3, v1
    v_lshlrev_b32 v38, 1, v2
    v_mul_u32_u24 v37, 0x1800, v2
    v_and_b32 v2, 3, v1
    v_lshl_add_u32 v38, v2, 6, v38
    v_and_b32 v2, 7, v1
    v_lshl_add_u32 v37, v2, 4, v37
    v_lshlrev_b32 v41, 4, v0
    v_mov_b32 v4, 0
    s_waitcnt lgkmcnt(0)
    s_mov_b32 s29, 0x213f80
    s_load_dword s45, s[26:27], s29
    s_cmp_lt_u32 s2, 64
    s_cbranch_scc0 adaLN_cond__spectral_gfnet__glu_gated_bilinear__prompt_kernel_L24
    s_mov_b32 s52, s20
    s_mov_b32 s53, s21
    s_mov_b32 s54, 0x300000
    s_mov_b32 s55, 0x00020000
    s_mov_b32 s56, s18
    s_mov_b32 s57, s19
    s_mov_b32 s58, 0x400
    s_mov_b32 s59, 0x00020000
    buffer_load_short_d16_hi v80, v38, s[56:59], s40 offen
    buffer_load_dwordx4 v[64:67], v37, s[52:55], s35 offen
    s_add_u32 s35, s35, 196608
    buffer_load_dwordx4 v[68:71], v37, s[52:55], s35 offen
    s_add_u32 s35, s35, 196608
    buffer_load_dwordx4 v[72:75], v37, s[52:55], s35 offen
    s_add_u32 s35, s35, 196608
    buffer_load_dwordx4 v[76:79], v37, s[52:55], s35 offen
adaLN_cond__spectral_gfnet__glu_gated_bilinear__prompt_kernel_L24:
    s_and_b32 s42, s2, 7
    s_lshl_b32 s42, s42, 5
    s_lshr_b32 s28, s2, 3
    s_add_u32 s42, s42, s28
    s_lshr_b32 s28, s42, 6
    s_lshl_b32 s43, s28, 4
    s_and_b32 s28, s42, 7
    s_lshl_b32 s28, s28, 1
    s_add_u32 s43, s43, s28
    s_bfe_u32 s28, s42, 0x10005
    s_lshl_b32 s28, s28, 10
    s_add_u32 s43, s43, s28
    s_bfe_u32 s28, s42, 0x20003
    s_lshl_b32 s28, s28, 8
    s_add_u32 s43, s43, s28
    s_mul_i32 s43, s43, 514
    s_mul_i32 s28, s3, 32896
    s_add_u32 s44, s43, s28
    s_mul_i32 s28, s3, 1040
    s_add_u32 s28, s28, 32768
    v_add_u32 v40, s28, v3
    s_mov_b32 s52, s6
    s_mov_b32 s53, s7
    s_mov_b32 s54, 0x101000
    s_mov_b32 s55, 0x00020000
    s_mov_b32 s56, s8
    s_mov_b32 s57, s9
    s_mov_b32 s58, 0x101000
    s_mov_b32 s59, 0x00020000
    buffer_load_dwordx4 v[92:95], v3, s[52:55], s44 offen
    buffer_load_dwordx4 v[100:103], v3, s[56:59], s44 offen
    s_mov_b64 exec, 1
    buffer_load_dword v45, v4, s[52:55], s44 offen offset:1024
    buffer_load_dword v46, v4, s[56:59], s44 offen offset:1024
    s_mov_b64 exec, -1
    v_cvt_f32_u32 v47, v24
    v_cvt_f32_u32 v108, v25
    v_mul_f32 v109, 0x3d000000, v47
    v_mul_f32 v110, 0x41000000, v108
    v_mul_f32 v110, v110, v109
    v_cos_f32 v111, v110
    v_sin_f32_e64 v113, -v110
    v_add_f32 v110, v110, v109
    v_cos_f32 v112, v110
    v_sin_f32_e64 v114, -v110
    v_add_f32 v110, v110, v109
    v_cvt_pk_bf16_f32 v116, v111, v112
    v_cvt_pk_bf16_f32 v120, v113, v114
    v_cos_f32 v111, v110
    v_sin_f32_e64 v113, -v110
    v_add_f32 v110, v110, v109
    v_cos_f32 v112, v110
    v_sin_f32_e64 v114, -v110
    v_add_f32 v110, v110, v109
    v_cvt_pk_bf16_f32 v117, v111, v112
    v_cvt_pk_bf16_f32 v121, v113, v114
    v_cos_f32 v111, v110
    v_sin_f32_e64 v113, -v110
    v_add_f32 v110, v110, v109
    v_cos_f32 v112, v110
    v_sin_f32_e64 v114, -v110
    v_add_f32 v110, v110, v109
    v_cvt_pk_bf16_f32 v118, v111, v112
    v_cvt_pk_bf16_f32 v122, v113, v114
    v_cos_f32 v111, v110
    v_sin_f32_e64 v113, -v110
    v_add_f32 v110, v110, v109
    v_cos_f32 v112, v110
    v_sin_f32_e64 v114, -v110
    v_add_f32 v110, v110, v109
    v_cvt_pk_bf16_f32 v119, v111, v112
    v_cvt_pk_bf16_f32 v123, v113, v114
    v_xor_b32 v124, 0x80000000, v116
    v_xor_b32 v128, 0x80000000, v120
    v_xor_b32 v125, 0x80000000, v117
    v_xor_b32 v129, 0x80000000, v121
    v_xor_b32 v126, 0x80000000, v118
    v_xor_b32 v130, 0x80000000, v122
    v_xor_b32 v127, 0x80000000, v119
    v_xor_b32 v131, 0x80000000, v123
    v_mul_f32 v115, 4.0, v108
    v_mul_f32 v109, 0x3b000000, v47
    v_mul_f32 v110, v115, v109
    v_cos_f32 v132, v110
    v_sin_f32 v140, v110
    v_add_f32 v110, v110, v109
    v_cos_f32 v133, v110
    v_sin_f32 v141, v110
    v_add_f32 v110, v110, v109
    v_cos_f32 v134, v110
    v_sin_f32 v142, v110
    v_add_f32 v110, v110, v109
    v_cos_f32 v135, v110
    v_sin_f32 v143, v110
    v_add_f32 v109, 0x3d000000, v109
    v_mul_f32 v110, v115, v109
    v_cos_f32 v136, v110
    v_sin_f32 v144, v110
    v_add_f32 v110, v110, v109
    v_cos_f32 v137, v110
    v_sin_f32 v145, v110
    v_add_f32 v110, v110, v109
    v_cos_f32 v138, v110
    v_sin_f32 v146, v110
    v_add_f32 v110, v110, v109
    v_cos_f32 v139, v110
    v_sin_f32 v147, v110
    v_lshrrev_b32 v2, 1, v24
    v_cvt_f32_u32 v109, v2
    v_mul_f32 v109, 0x3d800000, v109
    v_and_b32 v2, 1, v24
    v_cvt_f32_u32 v156, v2
    v_mul_f32 v156, 0x3e800000, v156
    v_add_f32 v157, 0xbe800000, v156
    v_mul_f32 v110, v115, v109
    v_mov_b32 v158, v110
    v_add_f32 v110, v110, v109
    v_mov_b32 v159, v110
    v_add_f32 v110, v110, v109
    v_mov_b32 v160, v110
    v_add_f32 v110, v110, v109
    v_mov_b32 v161, v110
    v_add_f32 v111, v158, v156
    v_add_f32 v112, v159, v156
    v_cos_f32 v111, v111
    v_cos_f32 v112, v112
    s_nop 0
    v_cvt_pk_bf16_f32 v148, v111, v112
    v_add_f32 v111, v160, v156
    v_add_f32 v112, v161, v156
    v_cos_f32 v111, v111
    v_cos_f32 v112, v112
    s_nop 0
    v_cvt_pk_bf16_f32 v149, v111, v112
    v_add_f32 v111, v158, v157
    v_add_f32 v112, v159, v157
    v_cos_f32 v111, v111
    v_cos_f32 v112, v112
    s_nop 0
    v_cvt_pk_bf16_f32 v150, v111, v112
    v_add_f32 v111, v160, v157
    v_add_f32 v112, v161, v157
    v_cos_f32 v111, v111
    v_cos_f32 v112, v112
    s_nop 0
    v_cvt_pk_bf16_f32 v151, v111, v112
    v_cmp_eq_u32 vcc, 0, v24
    v_mov_b32 v2, 0xbf803f80
    s_nop 0
    v_cndmask_b32 v152, 0, v2, vcc
    v_cndmask_b32 v153, 0, v2, vcc
    v_mov_b32 v154, 0
    v_mov_b32 v155, 0
    s_mul_i32 s28, s3, 1040
    s_add_u32 s28, s28, 6144
    v_lshlrev_b32 v162, 8, v25
    v_lshl_add_u32 v162, v24, 2, v162
    v_add_u32 v162, s28, v162
    v_and_b32 v2, 1, v0
    v_mul_u32_u24 v163, 4160, v2
    v_lshrrev_b32 v111, 1, v0
    v_lshl_add_u32 v163, v111, 2, v163
    v_add_u32 v163, 6144, v163
    s_lshl_b32 s46, s32, 13
    s_add_u32 s46, s46, 0x220000
    s_mul_i32 s28, s3, 2304
    s_add_u32 s28, s28, 16384
    v_lshrrev_b32 v2, 4, v1
    v_lshl_add_u32 v164, v2, 5, v3
    v_add_u32 v164, s28, v164
    v_mul_u32_u24 v165, 288, v25
    v_lshl_add_u32 v165, v24, 1, v165
    v_add_u32 v165, s28, v165
    v_and_b32 v2, 1, v0
    v_lshlrev_b32 v166, 9, v2
    v_lshrrev_b32 v167, 1, v0
    v_lshl_add_u32 v166, v167, 2, v166
    v_add_u32 v166, 32768, v166
    v_lshl_add_u32 v167, v2, 2, v166
    v_cmp_eq_u32 vcc, 1, v2
    v_mov_b32 v168, 0x05040100
    v_mov_b32 v169, 0x07060302
    v_cndmask_b32 v2, v168, v169, vcc
    v_cndmask_b32 v169, v169, v168, vcc
    v_mov_b32 v168, v2
    s_mov_b32 s36, s26
    s_mov_b32 s37, s27
    s_mov_b32 s38, 0x1400000
    s_mov_b32 s39, 0x00020000
    s_mov_b32 s48, s4
    s_mov_b32 s49, s5
    s_mov_b32 s50, 0x200000
    s_mov_b32 s51, 0x00020000
    buffer_load_dwordx4 v[48:51], v3, s[48:51], s33 offen offset:0
    buffer_load_dwordx4 v[56:59], v3, s[48:51], s33 offen offset:1024
    s_getpc_b64 s[60:61]
adaLN_cond__spectral_gfnet__glu_gated_bilinear__prompt_kernel_PC10:
    s_sub_u32 s28, s2, 64
    s_cmp_ge_u32 s28, 128
    s_cbranch_scc1 adaLN_cond__spectral_gfnet__glu_gated_bilinear__prompt_kernel_NOB11
    s_cmp_lg_u32 s3, 3
    s_cbranch_scc1 adaLN_cond__spectral_gfnet__glu_gated_bilinear__prompt_kernel_NOB11
    s_bfe_u32 s29, s2, 0x30003
    s_lshl_b32 s29, s29, 12
    v_lshlrev_b32 v172, 6, v1
    v_add_u32 v172, s29, v172
    v_min_u32 v172, adaLN_cond__spectral_gfnet__glu_gated_bilinear__prompt_kernel_CEND-adaLN_cond__spectral_gfnet__glu_gated_bilinear__prompt_kernel_PHB2-4, v172
    s_add_u32 s28, s60, adaLN_cond__spectral_gfnet__glu_gated_bilinear__prompt_kernel_PHB2-adaLN_cond__spectral_gfnet__glu_gated_bilinear__prompt_kernel_PC10
    s_addc_u32 s29, s61, 0
    v_mov_b32 v171, s29
    v_add_co_u32 v170, vcc, s28, v172
    s_nop 1
    v_addc_co_u32 v171, vcc, 0, v171, vcc
    global_load_dword v36, v[170:171], off
adaLN_cond__spectral_gfnet__glu_gated_bilinear__prompt_kernel_NOB11:
    v_and_b32 v42, 7, v1
    v_lshlrev_b32 v26, 3, v42
    v_bfe_u32 v42, v1, 3, 1
    v_lshl_add_u32 v26, v42, 2, v26
    v_bfe_u32 v42, v1, 4, 1
    v_lshl_add_u32 v26, v42, 1, v26
    v_lshrrev_b32 v42, 5, v1
    v_add_u32 v26, v26, v42
    v_lshlrev_b32 v26, 2, v26
    s_lshl_b32 s28, s3, 8
    v_add_u32 v26, s28, v26
    v_and_b32 v42, 8, v1
    v_cmp_ne_u32 s[62:63], 0, v42
    s_cmp_lt_u32 s2, 64
    s_cbranch_scc0 adaLN_cond__spectral_gfnet__glu_gated_bilinear__prompt_kernel_GX14
    s_waitcnt vmcnt(10)
    v_mul_f32 v170, 0xbfb8aa3b, v80
    v_exp_f32 v170, v170
    s_nop 0
    v_add_f32 v170, 1.0, v170
    v_rcp_f32 v170, v170
    s_nop 0
    v_mul_f32 v170, v80, v170
    v_cvt_pk_bf16_f32 v170, v170, v170
    v_and_b32 v27, 0xffff0000, v170
    s_nop 0
    s_nop 0
    v_mov_b32_dpp v172, v27 quad_perm:[0,0,0,0] row_mask:0xf bank_mask:0xf
    v_mov_b32_dpp v173, v27 quad_perm:[1,1,1,1] row_mask:0xf bank_mask:0xf
    v_mov_b32_dpp v174, v27 quad_perm:[2,2,2,2] row_mask:0xf bank_mask:0xf
    v_mov_b32_dpp v175, v27 quad_perm:[3,3,3,3] row_mask:0xf bank_mask:0xf
    s_waitcnt vmcnt(9)
    v_lshlrev_b32 v42, 16, v64
    v_and_b32 v43, 0xffff0000, v64
    v_mul_f32 v180, v172, v42
    v_mul_f32 v181, v172, v43
    v_lshlrev_b32 v42, 16, v65
    v_and_b32 v43, 0xffff0000, v65
    v_mul_f32 v182, v172, v42
    v_mul_f32 v183, v172, v43
    v_lshlrev_b32 v42, 16, v66
    v_and_b32 v43, 0xffff0000, v66
    v_mul_f32 v184, v172, v42
    v_mul_f32 v185, v172, v43
    v_lshlrev_b32 v42, 16, v67
    v_and_b32 v43, 0xffff0000, v67
    v_mul_f32 v186, v172, v42
    v_mul_f32 v187, v172, v43
    s_waitcnt vmcnt(8)
    v_lshlrev_b32 v42, 16, v68
    v_and_b32 v43, 0xffff0000, v68
    v_fmac_f32 v180, v173, v42
    v_fmac_f32 v181, v173, v43
    v_lshlrev_b32 v42, 16, v69
    v_and_b32 v43, 0xffff0000, v69
    v_fmac_f32 v182, v173, v42
    v_fmac_f32 v183, v173, v43
    v_lshlrev_b32 v42, 16, v70
    v_and_b32 v43, 0xffff0000, v70
    v_fmac_f32 v184, v173, v42
    v_fmac_f32 v185, v173, v43
    v_lshlrev_b32 v42, 16, v71
    v_and_b32 v43, 0xffff0000, v71
    v_fmac_f32 v186, v173, v42
    v_fmac_f32 v187, v173, v43
    s_waitcnt vmcnt(7)
    v_lshlrev_b32 v42, 16, v72
    v_and_b32 v43, 0xffff0000, v72
    v_fmac_f32 v180, v174, v42
    v_fmac_f32 v181, v174, v43
    v_lshlrev_b32 v42, 16, v73
    v_and_b32 v43, 0xffff0000, v73
    v_fmac_f32 v182, v174, v42
    v_fmac_f32 v183, v174, v43
    v_lshlrev_b32 v42, 16, v74
    v_and_b32 v43, 0xffff0000, v74
    v_fmac_f32 v184, v174, v42
    v_fmac_f32 v185, v174, v43
    v_lshlrev_b32 v42, 16, v75
    v_and_b32 v43, 0xffff0000, v75
    v_fmac_f32 v186, v174, v42
    v_fmac_f32 v187, v174, v43
    s_waitcnt vmcnt(6)
    v_lshlrev_b32 v42, 16, v76
    v_and_b32 v43, 0xffff0000, v76
    v_fmac_f32 v180, v175, v42
    v_fmac_f32 v181, v175, v43
    v_lshlrev_b32 v42, 16, v77
    v_and_b32 v43, 0xffff0000, v77
    v_fmac_f32 v182, v175, v42
    v_fmac_f32 v183, v175, v43
    v_lshlrev_b32 v42, 16, v78
    v_and_b32 v43, 0xffff0000, v78
    v_fmac_f32 v184, v175, v42
    v_fmac_f32 v185, v175, v43
    v_lshlrev_b32 v42, 16, v79
    v_and_b32 v43, 0xffff0000, v79
    v_fmac_f32 v186, v175, v42
    v_fmac_f32 v187, v175, v43
    v_permlane32_swap_b32 v180, v181
    v_permlane32_swap_b32 v182, v183
    v_permlane32_swap_b32 v184, v185
    v_permlane32_swap_b32 v186, v187
    v_add_f32 v180, v180, v181
    v_add_f32 v182, v182, v183
    v_add_f32 v184, v184, v185
    v_add_f32 v186, v186, v187
    v_permlane16_swap_b32 v180, v182
    s_nop 0
    v_permlane16_swap_b32 v184, v186
    v_add_f32 v180, v180, v182
    v_add_f32 v184, v184, v186
    s_nop 0
    v_add_f32_dpp v180, v180, v180 row_ror:8 row_mask:0xf bank_mask:0xf
    v_add_f32_dpp v184, v184, v184 row_ror:8 row_mask:0xf bank_mask:0xf
    v_cndmask_b32 v180, v180, v184, s[62:63]
    ds_write_b32 v26, v180 offset:0
    s_waitcnt lgkmcnt(0)
    s_barrier
    s_cmp_lg_u32 s3, 0
    s_cbranch_scc1 adaLN_cond__spectral_gfnet__glu_gated_bilinear__prompt_kernel_GX14
    v_lshlrev_b32 v170, 2, v1
    ds_read_b32 v188, v170 offset:0
    ds_read_b32 v189, v170 offset:256
    ds_read_b32 v190, v170 offset:512
    ds_read_b32 v191, v170 offset:768
    s_mul_i32 s34, s45, 0x2c9277b5
    s_add_u32 s34, s34, 0x7f4a7c15
    s_and_b32 s43, s34, 3
    s_waitcnt lgkmcnt(0)
    v_add_f32 v188, v188, v189
    v_add_f32 v190, v190, v191
    v_add_f32 v188, v188, v190
    v_and_b32 v188, -4, v188
    v_or_b32 v188, s43, v188
    buffer_store_dword v188, v170, s[36:39], s41 offen sc1
    s_waitcnt vmcnt(1)
    s_branch adaLN_cond__spectral_gfnet__glu_gated_bilinear__prompt_kernel_GX219
adaLN_cond__spectral_gfnet__glu_gated_bilinear__prompt_kernel_GX14:
    s_waitcnt vmcnt(0)
adaLN_cond__spectral_gfnet__glu_gated_bilinear__prompt_kernel_GX219:
    ds_write_b128 v40, v[92:95]
    ds_write_b128 v40, v[100:103] offset:4160
    s_mov_b64 exec, 1
    ds_write_b32 v40, v45 offset:1024
    ds_write_b32 v40, v46 offset:5184
    s_mov_b64 exec, -1
    s_waitcnt lgkmcnt(0)
    s_barrier
    ds_write_b128 v164, v[48:51] offset:0
    ds_write_b128 v164, v[56:59] offset:1152
    ds_read_u16_d16_hi v48, v165 offset:0
    ds_read_u16_d16_hi v49, v165 offset:32
    ds_read_u16_d16_hi v50, v165 offset:64
    ds_read_u16_d16_hi v51, v165 offset:96
    ds_read_u16_d16_hi v52, v165 offset:128
    ds_read_u16_d16_hi v53, v165 offset:160
    ds_read_u16_d16_hi v54, v165 offset:192
    ds_read_u16_d16_hi v55, v165 offset:224
    ds_read_u16_d16_hi v56, v165 offset:1152
    ds_read_u16_d16_hi v57, v165 offset:1184
    ds_read_u16_d16_hi v58, v165 offset:1216
    ds_read_u16_d16_hi v59, v165 offset:1248
    ds_read_u16_d16_hi v60, v165 offset:1280
    ds_read_u16_d16_hi v61, v165 offset:1312
    ds_read_u16_d16_hi v62, v165 offset:1344
    ds_read_u16_d16_hi v63, v165 offset:1376
    ds_read_b32 v92, v166 offset:0
    ds_read_b32 v100, v166 offset:4160
    ds_read_b32 v93, v166 offset:1040
    ds_read_b32 v101, v166 offset:5200
    ds_read_b32 v94, v166 offset:2080
    ds_read_b32 v102, v166 offset:6240
    ds_read_b32 v95, v166 offset:3120
    ds_read_b32 v103, v166 offset:7280
    ds_read_b32 v200, v167 offset:0
    ds_read_b32 v204, v167 offset:4160
    ds_read_b32 v201, v167 offset:1040
    ds_read_b32 v205, v167 offset:5200
    ds_read_b32 v202, v167 offset:2080
    ds_read_b32 v206, v167 offset:6240
    ds_read_b32 v203, v167 offset:3120
    ds_read_b32 v207, v167 offset:7280
    v_and_b32 v42, 3, v1
    v_mul_u32_u24 v42, 1040, v42
    v_bfe_u32 v43, v1, 2, 1
    v_lshl_add_u32 v42, v43, 9, v42
    ds_read_b32 v208, v42 offset:33280
    ds_read_b32 v209, v42 offset:37440
    v_cmp_eq_u32 vcc, 1, v43
    v_mov_b32 v42, 0x05040100
    v_mov_b32 v43, 0x07060302
    v_cndmask_b32 v43, v42, v43, vcc
    s_lshl_b32 s44, s42, 13
    s_waitcnt lgkmcnt(0)
    v_perm_b32 v192, v100, v92, v168
    v_perm_b32 v196, v204, v200, v169
    v_perm_b32 v193, v101, v93, v168
    v_perm_b32 v197, v205, v201, v169
    v_perm_b32 v194, v102, v94, v168
    v_perm_b32 v198, v206, v202, v169
    v_perm_b32 v195, v103, v95, v168
    v_perm_b32 v199, v207, v203, v169
    v_perm_b32 v208, v209, v208, v43
    buffer_store_dwordx4 v[192:195], v41, s[36:39], s44 offen sc1
    s_add_u32 s44, s44, 4096
    buffer_store_dwordx4 v[196:199], v41, s[36:39], s44 offen sc1
    s_lshl_b32 s28, s42, 5
    s_add_u32 s28, s28, 0x200000
    v_lshlrev_b32 v44, 2, v0
    v_cmp_gt_u32 vcc, 8, v0
    s_nop 0
    s_and_saveexec_b64 s[60:61], vcc
    buffer_store_dword v208, v44, s[36:39], s28 offen sc1
    s_mov_b64 exec, s[60:61]
    s_waitcnt lgkmcnt(0)
    s_mul_i32 s34, s45, 0x2c9277b5
    s_add_u32 s34, s34, 0x7f4a7c15
    s_and_b32 s43, s34, 3
    v_add_f32 v171, v48, v49
    v_add_f32 v211, v50, v51
    v_add_f32 v111, v52, v53
    v_add_f32 v113, v54, v55
    v_add_f32 v210, v56, v57
    v_add_f32 v212, v58, v59
    v_add_f32 v112, v60, v61
    v_add_f32 v114, v62, v63
    v_add_f32 v171, v171, v211
    v_add_f32 v111, v111, v113
    v_add_f32 v210, v210, v212
    v_add_f32 v112, v112, v114
    v_add_f32 v171, v171, v111
    v_add_f32 v210, v210, v112
    s_nop 0
    v_add_f32_dpp v171, v171, v171 row_ror:8 row_mask:0xf bank_mask:0xf
    v_add_f32_dpp v210, v210, v210 row_ror:8 row_mask:0xf bank_mask:0xf
    s_nop 0
    v_add_f32_dpp v171, v171, v171 row_ror:4 row_mask:0xf bank_mask:0xf
    v_add_f32_dpp v210, v210, v210 row_ror:4 row_mask:0xf bank_mask:0xf
    s_nop 0
    v_add_f32_dpp v171, v171, v171 row_ror:2 row_mask:0xf bank_mask:0xf
    v_add_f32_dpp v210, v210, v210 row_ror:2 row_mask:0xf bank_mask:0xf
    s_nop 0
    v_add_f32_dpp v171, v171, v171 row_ror:1 row_mask:0xf bank_mask:0xf
    v_add_f32_dpp v210, v210, v210 row_ror:1 row_mask:0xf bank_mask:0xf
    v_mov_b32 v211, v171
    v_mov_b32 v212, v210
    s_nop 0
    v_permlane16_swap_b32 v171, v211
    v_permlane16_swap_b32 v210, v212
    v_add_f32 v171, v171, v211
    v_add_f32 v210, v210, v212
    v_mov_b32 v211, v171
    v_mov_b32 v212, v210
    s_nop 0
    v_permlane32_swap_b32 v171, v211
    v_permlane32_swap_b32 v210, v212
    v_add_f32 v171, v171, v211
    v_add_f32 v210, v210, v212
    v_mul_f32 v171, 0xbb000000, v171
    v_mul_f32 v210, 0xbb000000, v210
    v_add_f32 v48, v48, v171
    v_add_f32 v49, v49, v171
    v_add_f32 v50, v50, v171
    v_add_f32 v51, v51, v171
    v_add_f32 v52, v52, v171
    v_add_f32 v53, v53, v171
    v_add_f32 v54, v54, v171
    v_add_f32 v55, v55, v171
    v_add_f32 v56, v56, v210
    v_add_f32 v57, v57, v210
    v_add_f32 v58, v58, v210
    v_add_f32 v59, v59, v210
    v_add_f32 v60, v60, v210
    v_add_f32 v61, v61, v210
    v_add_f32 v62, v62, v210
    v_add_f32 v63, v63, v210
    v_mul_f32 v171, v48, v48
    v_mul_f32 v111, v49, v49
    v_mul_f32 v210, v56, v56
    v_mul_f32 v112, v57, v57
    v_fmac_f32 v171, v50, v50
    v_fmac_f32 v111, v51, v51
    v_fmac_f32 v210, v58, v58
    v_fmac_f32 v112, v59, v59
    v_fmac_f32 v171, v52, v52
    v_fmac_f32 v111, v53, v53
    v_fmac_f32 v210, v60, v60
    v_fmac_f32 v112, v61, v61
    v_fmac_f32 v171, v54, v54
    v_fmac_f32 v111, v55, v55
    v_fmac_f32 v210, v62, v62
    v_fmac_f32 v112, v63, v63
    v_add_f32 v171, v171, v111
    v_add_f32 v210, v210, v112
    s_nop 0
    v_add_f32_dpp v171, v171, v171 row_ror:8 row_mask:0xf bank_mask:0xf
    v_add_f32_dpp v210, v210, v210 row_ror:8 row_mask:0xf bank_mask:0xf
    s_nop 0
    v_add_f32_dpp v171, v171, v171 row_ror:4 row_mask:0xf bank_mask:0xf
    v_add_f32_dpp v210, v210, v210 row_ror:4 row_mask:0xf bank_mask:0xf
    s_nop 0
    v_add_f32_dpp v171, v171, v171 row_ror:2 row_mask:0xf bank_mask:0xf
    v_add_f32_dpp v210, v210, v210 row_ror:2 row_mask:0xf bank_mask:0xf
    s_nop 0
    v_add_f32_dpp v171, v171, v171 row_ror:1 row_mask:0xf bank_mask:0xf
    v_add_f32_dpp v210, v210, v210 row_ror:1 row_mask:0xf bank_mask:0xf
    v_mov_b32 v211, v171
    v_mov_b32 v212, v210
    s_nop 0
    v_permlane16_swap_b32 v171, v211
    v_permlane16_swap_b32 v210, v212
    v_add_f32 v171, v171, v211
    v_add_f32 v210, v210, v212
    v_mov_b32 v211, v171
    v_mov_b32 v212, v210
    s_nop 0
    v_permlane32_swap_b32 v171, v211
    v_permlane32_swap_b32 v210, v212
    v_add_f32 v171, v171, v211
    v_add_f32 v210, v210, v212
    v_mov_b32 v211, 0x3727c5ac
    v_fmac_f32 v211, 0x3b000000, v171
    v_mov_b32 v212, 0x3727c5ac
    v_fmac_f32 v212, 0x3b000000, v210
    v_rsq_f32 v211, v211
    v_rsq_f32 v212, v212
    v_mul_f32 v48, v48, v211
    v_mul_f32 v49, v49, v211
    v_mul_f32 v50, v50, v211
    v_mul_f32 v51, v51, v211
    v_mul_f32 v52, v52, v211
    v_mul_f32 v53, v53, v211
    v_mul_f32 v54, v54, v211
    v_mul_f32 v55, v55, v211
    v_mul_f32 v56, v56, v212
    v_mul_f32 v57, v57, v212
    v_mul_f32 v58, v58, v212
    v_mul_f32 v59, v59, v212
    v_mul_f32 v60, v60, v212
    v_mul_f32 v61, v61, v212
    v_mul_f32 v62, v62, v212
    v_mul_f32 v63, v63, v212
    s_lshl_b32 s28, s3, 10
    v_lshl_add_u32 v213, v1, 4, s28
    s_lshr_b32 s28, s3, 1
    s_lshl_b32 s28, s28, 11
    s_and_b32 s29, s3, 1
    s_lshl_b32 s29, s29, 9
    s_add_u32 s28, s28, s29
    s_add_u32 s28, s28, 2048
    v_lshrrev_b32 v42, 5, v1
    v_lshlrev_b32 v214, 8, v42
    v_and_b32 v42, 3, v1
    v_lshl_add_u32 v214, v42, 6, v214
    v_bfe_u32 v42, v1, 2, 2
    v_lshl_add_u32 v214, v42, 2, v214
    v_bfe_u32 v42, v1, 4, 1
    v_lshl_add_u32 v214, v42, 10, v214
    v_add_u32 v214, s28, v214
    s_mov_b32 s29, 0
    s_and_b32 s64, s2, 0
    s_lshl_b32 s64, s64, 14
    s_add_u32 s64, s64, 0x214000
    s_add_u32 s65, s64, 0x1000
    s_add_u32 s66, s64, 0x2000
    s_add_u32 s67, s64, 0x3000
adaLN_cond__spectral_gfnet__glu_gated_bilinear__prompt_kernel_POLL21:
    buffer_load_dwordx4 v[216:219], v213, s[36:39], s64 offen sc1
    buffer_load_dwordx4 v[220:223], v213, s[36:39], s65 offen sc1
    buffer_load_dwordx4 v[224:227], v213, s[36:39], s66 offen sc1
    buffer_load_dwordx4 v[228:231], v213, s[36:39], s67 offen sc1
    s_add_u32 s29, s29, 1
    s_waitcnt vmcnt(0)
    v_xor_b32 v216, s43, v216
    v_xor_b32 v217, s43, v217
    v_xor_b32 v218, s43, v218
    v_xor_b32 v219, s43, v219
    v_xor_b32 v220, s43, v220
    v_xor_b32 v221, s43, v221
    v_xor_b32 v222, s43, v222
    v_xor_b32 v223, s43, v223
    v_xor_b32 v224, s43, v224
    v_xor_b32 v225, s43, v225
    v_xor_b32 v226, s43, v226
    v_xor_b32 v227, s43, v227
    v_xor_b32 v228, s43, v228
    v_xor_b32 v229, s43, v229
    v_xor_b32 v230, s43, v230
    v_xor_b32 v231, s43, v231
    v_or3_b32 v42, v216, v217, v218
    v_or3_b32 v43, v219, v220, v221
    v_or3_b32 v42, v42, v222, v223
    v_or3_b32 v43, v43, v224, v225
    v_or3_b32 v42, v42, v226, v227
    v_or3_b32 v43, v43, v228, v229
    v_or3_b32 v42, v42, v230, v231
    v_or_b32 v42, v42, v43
    v_and_b32 v42, 3, v42
    v_cmp_ne_u32 vcc, 0, v42
    s_nop 0
    s_cbranch_vccz adaLN_cond__spectral_gfnet__glu_gated_bilinear__prompt_kernel_PDONE22
    s_cmp_lt_u32 s29, 0x40000
    s_cbranch_scc1 adaLN_cond__spectral_gfnet__glu_gated_bilinear__prompt_kernel_POLL21
adaLN_cond__spectral_gfnet__glu_gated_bilinear__prompt_kernel_PDONE22:
    s_cmp_lt_u32 s2, 192
    s_cbranch_scc1 adaLN_cond__spectral_gfnet__glu_gated_bilinear__prompt_kernel_NONC26
    s_mov_b32 s52, s20
    s_mov_b32 s53, s21
    s_mov_b32 s54, 0x300000
    s_mov_b32 s55, 0x00020000
    s_mov_b32 s56, s18
    s_mov_b32 s57, s19
    s_mov_b32 s58, 0x400
    s_mov_b32 s59, 0x00020000
    buffer_load_short_d16_hi v28, v38, s[56:59], s40 offen offset:0
    buffer_load_short_d16_hi v29, v38, s[56:59], s40 offen offset:256
    buffer_load_dwordx4 a[0:3], v37, s[52:55], s35 offen
    s_add_u32 s35, s35, 196608
    buffer_load_dwordx4 a[4:7], v37, s[52:55], s35 offen
    s_add_u32 s35, s35, 196608
    buffer_load_dwordx4 a[8:11], v37, s[52:55], s35 offen
    s_add_u32 s35, s35, 196608
    buffer_load_dwordx4 a[12:15], v37, s[52:55], s35 offen
    s_add_u32 s35, s35, 196608
    buffer_load_dwordx4 a[16:19], v37, s[52:55], s35 offen
    s_add_u32 s35, s35, 196608
    buffer_load_dwordx4 a[20:23], v37, s[52:55], s35 offen
    s_add_u32 s35, s35, 196608
    buffer_load_dwordx4 a[24:27], v37, s[52:55], s35 offen
    s_add_u32 s35, s35, 196608
    buffer_load_dwordx4 a[28:31], v37, s[52:55], s35 offen
adaLN_cond__spectral_gfnet__glu_gated_bilinear__prompt_kernel_NONC26:
    v_add_f32 v216, v216, v220
    v_add_f32 v224, v224, v228
    v_add_f32 v217, v217, v221
    v_add_f32 v225, v225, v229
    v_add_f32 v218, v218, v222
    v_add_f32 v226, v226, v230
    v_add_f32 v219, v219, v223
    v_add_f32 v227, v227, v231
    v_add_f32 v216, v216, v224
    v_add_f32 v217, v217, v225
    v_add_f32 v218, v218, v226
    v_add_f32 v219, v219, v227
    s_cmp_ge_u32 s3, 2
    s_cselect_b32 s28, 1.0, 0
    v_cvt_pk_bf16_f32 v220, v216, v217
    v_cvt_pk_bf16_f32 v221, v218, v219
    v_lshlrev_b32 v216, 16, v220
    v_and_b32 v217, 0xffff0000, v220
    v_lshlrev_b32 v218, 16, v221
    v_and_b32 v219, 0xffff0000, v221
    v_add_f32 v216, s28, v216
    v_add_f32 v217, s28, v217
    v_add_f32 v218, s28, v218
    v_add_f32 v219, s28, v219
    v_cvt_pk_bf16_f32 v220, v216, v217
    v_cvt_pk_bf16_f32 v221, v218, v219
    v_lshlrev_b32 v216, 16, v220
    v_and_b32 v217, 0xffff0000, v220
    v_lshlrev_b32 v218, 16, v221
    v_and_b32 v219, 0xffff0000, v221
    ds_write_b32 v214, v216 offset:0
    ds_write_b32 v214, v217 offset:16
    ds_write_b32 v214, v218 offset:32
    ds_write_b32 v214, v219 offset:48
    s_waitcnt lgkmcnt(0)
    s_barrier
    ds_read_b128 v[240:243], v3 offset:2048
    ds_read_b128 v[232:235], v3 offset:4096
    ds_read_b128 v[244:247], v3 offset:3072
    ds_read_b128 v[236:239], v3 offset:5120
    s_waitcnt lgkmcnt(2)
    v_fma_f32 v48, v48, v232, v240
    v_fma_f32 v49, v49, v233, v241
    v_fma_f32 v50, v50, v234, v242
    v_fma_f32 v51, v51, v235, v243
    v_fma_f32 v56, v56, v232, v240
    v_fma_f32 v57, v57, v233, v241
    v_fma_f32 v58, v58, v234, v242
    v_fma_f32 v59, v59, v235, v243
    s_waitcnt lgkmcnt(0)
    v_fma_f32 v52, v52, v236, v244
    v_fma_f32 v53, v53, v237, v245
    v_fma_f32 v54, v54, v238, v246
    v_fma_f32 v55, v55, v239, v247
    v_fma_f32 v60, v60, v236, v244
    v_fma_f32 v61, v61, v237, v245
    v_fma_f32 v62, v62, v238, v246
    v_fma_f32 v63, v63, v239, v247
    v_cvt_pk_bf16_f32 v216, v48, v49
    v_cvt_pk_bf16_f32 v217, v50, v51
    v_cvt_pk_bf16_f32 v218, v52, v53
    v_cvt_pk_bf16_f32 v219, v54, v55
    v_cvt_pk_bf16_f32 v220, v56, v57
    v_cvt_pk_bf16_f32 v221, v58, v59
    v_cvt_pk_bf16_f32 v222, v60, v61
    v_cvt_pk_bf16_f32 v223, v62, v63
    v_mfma_f32_16x16x32_bf16 v[64:67], v[216:219], v[116:119], 0
    v_mfma_f32_16x16x32_bf16 v[172:175], v[216:219], v[120:123], 0
    v_mfma_f32_16x16x32_bf16 v[72:75], v[220:223], v[116:119], 0
    v_mfma_f32_16x16x32_bf16 v[80:83], v[220:223], v[120:123], 0
    v_mfma_f32_16x16x32_bf16 v[68:71], v[216:219], v[124:127], 0
    v_mfma_f32_16x16x32_bf16 v[176:179], v[216:219], v[128:131], 0
    v_mfma_f32_16x16x32_bf16 v[76:79], v[220:223], v[124:127], 0
    v_mfma_f32_16x16x32_bf16 v[84:87], v[220:223], v[128:131], 0
    s_nop 0
    v_mul_f32 v192, v64, v132
    v_mul_f32 v196, v172, v132
    v_mul_f32 v193, v65, v133
    v_mul_f32 v197, v173, v133
    v_mul_f32 v194, v66, v134
    v_mul_f32 v198, v174, v134
    v_mul_f32 v195, v67, v135
    v_mul_f32 v199, v175, v135
    v_fmac_f32 v192, v172, v140
    v_fma_f32 v196, -v64, v140, v196
    v_fmac_f32 v193, v173, v141
    v_fma_f32 v197, -v65, v141, v197
    v_fmac_f32 v194, v174, v142
    v_fma_f32 v198, -v66, v142, v198
    v_fmac_f32 v195, v175, v143
    v_fma_f32 v199, -v67, v143, v199
    v_cvt_pk_bf16_f32 v92, v192, v193
    v_cvt_pk_bf16_f32 v93, v194, v195
    v_cvt_pk_bf16_f32 v94, v196, v197
    v_cvt_pk_bf16_f32 v95, v198, v199
    s_nop 1
    v_mfma_f32_16x16x32_bf16 v[48:51], v[148:151], v[92:95], 0
    v_mfma_f32_16x16x32_bf16 v[224:227], v[152:155], v[92:95], 0
    v_mul_f32 v180, v72, v132
    v_mul_f32 v184, v80, v132
    v_mul_f32 v181, v73, v133
    v_mul_f32 v185, v81, v133
    v_mul_f32 v182, v74, v134
    v_mul_f32 v186, v82, v134
    v_mul_f32 v183, v75, v135
    v_mul_f32 v187, v83, v135
    v_fmac_f32 v180, v80, v140
    v_fma_f32 v184, -v72, v140, v184
    v_fmac_f32 v181, v81, v141
    v_fma_f32 v185, -v73, v141, v185
    v_fmac_f32 v182, v82, v142
    v_fma_f32 v186, -v74, v142, v186
    v_fmac_f32 v183, v83, v143
    v_fma_f32 v187, -v75, v143, v187
    v_cvt_pk_bf16_f32 v96, v180, v181
    v_cvt_pk_bf16_f32 v97, v182, v183
    v_cvt_pk_bf16_f32 v98, v184, v185
    v_cvt_pk_bf16_f32 v99, v186, v187
    s_nop 1
    v_mfma_f32_16x16x32_bf16 v[56:59], v[148:151], v[96:99], 0
    v_mfma_f32_16x16x32_bf16 v[228:231], v[152:155], v[96:99], 0
    v_mul_f32 v192, v68, v136
    v_mul_f32 v196, v176, v136
    v_mul_f32 v193, v69, v137
    v_mul_f32 v197, v177, v137
    v_mul_f32 v194, v70, v138
    v_mul_f32 v198, v178, v138
    v_mul_f32 v195, v71, v139
    v_mul_f32 v199, v179, v139
    v_fmac_f32 v192, v176, v144
    v_fma_f32 v196, -v68, v144, v196
    v_fmac_f32 v193, v177, v145
    v_fma_f32 v197, -v69, v145, v197
    v_fmac_f32 v194, v178, v146
    v_fma_f32 v198, -v70, v146, v198
    v_fmac_f32 v195, v179, v147
    v_fma_f32 v199, -v71, v147, v199
    v_cvt_pk_bf16_f32 v100, v192, v193
    v_cvt_pk_bf16_f32 v101, v194, v195
    v_cvt_pk_bf16_f32 v102, v196, v197
    v_cvt_pk_bf16_f32 v103, v198, v199
    s_nop 1
    v_mfma_f32_16x16x32_bf16 v[52:55], v[148:151], v[100:103], 0
    v_mul_f32 v180, v76, v136
    v_mul_f32 v184, v84, v136
    v_mul_f32 v181, v77, v137
    v_mul_f32 v185, v85, v137
    v_mul_f32 v182, v78, v138
    v_mul_f32 v186, v86, v138
    v_mul_f32 v183, v79, v139
    v_mul_f32 v187, v87, v139
    v_fmac_f32 v180, v84, v144
    v_fma_f32 v184, -v76, v144, v184
    v_fmac_f32 v181, v85, v145
    v_fma_f32 v185, -v77, v145, v185
    v_fmac_f32 v182, v86, v146
    v_fma_f32 v186, -v78, v146, v186
    v_fmac_f32 v183, v87, v147
    v_fma_f32 v187, -v79, v147, v187
    v_cvt_pk_bf16_f32 v104, v180, v181
    v_cvt_pk_bf16_f32 v105, v182, v183
    v_cvt_pk_bf16_f32 v106, v184, v185
    v_cvt_pk_bf16_f32 v107, v186, v187
    s_nop 1
    v_mfma_f32_16x16x32_bf16 v[60:63], v[148:151], v[104:107], 0
    v_cmp_eq_u32 vcc, 0, v1
    s_nop 1
    v_cndmask_b32 v49, v49, v224, vcc
    v_cndmask_b32 v57, v57, v228, vcc
    v_cvt_pk_bf16_f32 v232, v48, v49
    v_cvt_pk_bf16_f32 v233, v50, v51
    v_cvt_pk_bf16_f32 v234, v52, v53
    v_cvt_pk_bf16_f32 v235, v54, v55
    ds_write_b32 v162, v232 offset:0
    ds_write_b32 v162, v233 offset:128
    ds_write_b32 v162, v234 offset:64
    ds_write_b32 v162, v235 offset:192
    v_cvt_pk_bf16_f32 v236, v56, v57
    v_cvt_pk_bf16_f32 v237, v58, v59
    v_cvt_pk_bf16_f32 v238, v60, v61
    v_cvt_pk_bf16_f32 v239, v62, v63
    ds_write_b32 v162, v236 offset:4160
    ds_write_b32 v162, v237 offset:4288
    ds_write_b32 v162, v238 offset:4224
    ds_write_b32 v162, v239 offset:4352
    s_waitcnt lgkmcnt(0)
    s_barrier
    ds_read_b32 v240, v163 offset:0
    ds_read_b32 v241, v163 offset:1040
    ds_read_b32 v242, v163 offset:2080
    ds_read_b32 v243, v163 offset:3120
    ds_read_b32 v244, v163 offset:512
    ds_read_b32 v245, v163 offset:1552
    ds_read_b32 v246, v163 offset:2592
    ds_read_b32 v247, v163 offset:3632
    s_waitcnt lgkmcnt(4)
    buffer_store_dwordx4 v[240:243], v41, s[36:39], s46 offen offset:0 sc1
    s_add_u32 s46, s46, 4096
    s_waitcnt lgkmcnt(0)
    buffer_store_dwordx4 v[244:247], v41, s[36:39], s46 offen offset:0 sc1
    s_lshl_b32 s47, s2, 2
    s_add_u32 s47, s47, 0x1312000
    v_mov_b32 v6, s34
    v_lshlrev_b32 v5, 10, v1
    s_waitcnt vmcnt(0)
    s_barrier
    s_cmp_lg_u32 s3, 0
    s_cbranch_scc1 adaLN_cond__spectral_gfnet__glu_gated_bilinear__prompt_kernel_PUBA27
    s_mov_b64 exec, 255
    buffer_store_dword v6, v5, s[36:39], s47 offen sc1
    s_mov_b64 exec, -1
adaLN_cond__spectral_gfnet__glu_gated_bilinear__prompt_kernel_PUBA27:
adaLN_cond__spectral_gfnet__glu_gated_bilinear__prompt_kernel_PHB2:
    s_and_b32 s6, s2, 7
    s_lshl_b32 s6, s6, 5
    s_lshr_b32 s28, s2, 3
    s_add_u32 s6, s6, s28
    s_lshl_b32 s10, s6, 13
    s_lshl_b32 s28, s3, 10
    s_add_u32 s10, s10, s28
    s_add_u32 s10, s10, 0x430000
    s_lshl_b32 s28, s3, 11
    s_add_u32 s9, s28, 0x200000
    s_lshl_b32 s28, s3, 19
    s_lshr_b32 s29, s6, 1
    s_lshl_b32 s29, s29, 5
    s_add_u32 s8, s28, s29
    s_and_b32 s29, s6, 1
    s_lshl_b32 s29, s29, 12
    s_add_u32 s8, s8, s29
    s_add_u32 s8, s8, 0x0
    s_lshl_b32 s29, s6, 5
    s_add_u32 s7, s29, 0x220000
    s_add_u32 s7, s7, s28
    s_lshl_b32 s28, s3, 10
    v_add_u32 v44, 4096, v3
    s_add_u32 s28, s28, 115712
    v_add_u32 v45, s28, v3
    v_add_u32 v46, 115712, v3
    v_lshlrev_b32 v27, 5, v24
    v_lshl_add_u32 v27, v25, 3, v27
    v_lshrrev_b32 v49, 3, v1
    v_bfe_u32 v2, v1, 4, 1
    v_lshlrev_b32 v2, 2, v2
    v_and_b32 v47, 7, v1
    v_xor_b32 v47, v47, v2
    v_lshlrev_b32 v47, 4, v47
    v_lshl_add_u32 v47, v49, 10, v47
    s_sub_u32 s28, s2, 32
    s_cselect_b32 s28, 0, s28
    s_and_b32 s29, s28, 1
    s_lshl_b32 s29, s29, 2
    s_add_u32 s29, s29, s3
    s_lshr_b32 s28, s28, 1
    s_lshl_b32 s6, s28, 14
    s_lshl_b32 s11, s29, 7
    s_add_u32 s6, s6, s11
    s_mul_i32 s11, s29, 229376
    s_lshl_b32 s28, s28, 11
    s_add_u32 s11, s11, s28
    s_add_u32 s11, s11, 0x1140000
    v_add_u32 v48, 7168, v47
    v_lshlrev_b32 v49, 5, v0
    s_mul_i32 s28, s2, 7168
    s_and_b32 s29, s3, 1
    s_lshl_b32 s29, s29, 12
    s_add_u32 s28, s28, s29
    v_lshl_add_u32 v50, v3, 2, s28
    s_lshl_b32 s29, s3, 11
    s_add_u32 s29, s29, 132608
    s_mov_b32 m0, s29
    s_mov_b32 s48, s16
    s_mov_b32 s49, s17
    s_mov_b32 s50, 0x1c0000
    s_mov_b32 s51, 0x00020000
    s_cmp_lt_u32 s2, 32
    s_cbranch_scc1 adaLN_cond__spectral_gfnet__glu_gated_bilinear__prompt_kernel_NOE28
    s_cmp_eq_u32 s3, 0
    s_cbranch_scc1 adaLN_cond__spectral_gfnet__glu_gated_bilinear__prompt_kernel_NOE28
    buffer_load_dwordx4 v47, s[48:51], s6 offen lds
    buffer_load_dwordx4 v48, s[48:51], s6 offen offset:1024 lds
    s_cmp_lg_u32 s3, 3
    s_cbranch_scc1 adaLN_cond__spectral_gfnet__glu_gated_bilinear__prompt_kernel_N329
    s_mov_b32 m0, 132608
    s_sub_u32 s28, s6, 384
    buffer_load_dwordx4 v47, s[48:51], s28 offen lds
    buffer_load_dwordx4 v48, s[48:51], s28 offen offset:1024 lds
    s_branch adaLN_cond__spectral_gfnet__glu_gated_bilinear__prompt_kernel_NOE28
adaLN_cond__spectral_gfnet__glu_gated_bilinear__prompt_kernel_N329:
adaLN_cond__spectral_gfnet__glu_gated_bilinear__prompt_kernel_NOE28:
    v_cvt_f32_u32 v51, v24
    v_cvt_f32_u32 v52, v25
    v_mul_f32 v52, 4.0, v52
    s_lshl_b32 s28, s3, 4
    v_add_u32 v2, s28, v24
    v_cvt_f32_u32 v53, v2
    v_and_b32 v2, 1, v24
    v_mul_u32_u24 v61, 0x8000, v2
    v_lshl_or_b32 v61, v61, 16, v61
    v_mul_f32 v54, 0x3c800000, v53
    v_mul_f32 v55, 0x41500000, v54
    v_mul_f32 v56, v52, v54
    v_cos_f32 v57, v56
    v_sin_f32 v58, v56
    v_add_f32 v56, v56, v54
    v_cvt_pk_bf16_f32 v64, v57, v58
    v_cvt_pk_bf16_f32 v80, -v58, v57
    v_cos_f32 v59, v56
    v_sin_f32 v60, v56
    v_add_f32 v56, v56, v54
    v_cvt_pk_bf16_f32 v65, v59, v60
    v_cvt_pk_bf16_f32 v81, -v60, v59
    v_cos_f32 v57, v56
    v_sin_f32 v58, v56
    v_add_f32 v56, v56, v54
    v_cvt_pk_bf16_f32 v66, v57, v58
    v_cvt_pk_bf16_f32 v82, -v58, v57
    v_cos_f32 v59, v56
    v_sin_f32 v60, v56
    v_add_f32 v56, v56, v55
    v_cvt_pk_bf16_f32 v67, v59, v60
    v_cvt_pk_bf16_f32 v83, -v60, v59
    v_cos_f32 v57, v56
    v_sin_f32 v58, v56
    v_add_f32 v56, v56, v54
    v_cvt_pk_bf16_f32 v68, v57, v58
    v_cvt_pk_bf16_f32 v84, -v58, v57
    v_cos_f32 v59, v56
    v_sin_f32 v60, v56
    v_add_f32 v56, v56, v54
    v_cvt_pk_bf16_f32 v69, v59, v60
    v_cvt_pk_bf16_f32 v85, -v60, v59
    v_cos_f32 v57, v56
    v_sin_f32 v58, v56
    v_add_f32 v56, v56, v54
    v_cvt_pk_bf16_f32 v70, v57, v58
    v_cvt_pk_bf16_f32 v86, -v58, v57
    v_cos_f32 v59, v56
    v_sin_f32 v60, v56
    s_nop 0
    v_cvt_pk_bf16_f32 v71, v59, v60
    v_cvt_pk_bf16_f32 v87, -v60, v59
    v_xor_b32 v72, v61, v64
    v_xor_b32 v88, v61, v80
    v_xor_b32 v73, v61, v65
    v_xor_b32 v89, v61, v81
    v_xor_b32 v74, v61, v66
    v_xor_b32 v90, v61, v82
    v_xor_b32 v75, v61, v67
    v_xor_b32 v91, v61, v83
    v_xor_b32 v76, v61, v68
    v_xor_b32 v92, v61, v84
    v_xor_b32 v77, v61, v69
    v_xor_b32 v93, v61, v85
    v_xor_b32 v78, v61, v70
    v_xor_b32 v94, v61, v86
    v_xor_b32 v79, v61, v71
    v_xor_b32 v95, v61, v87
    v_mul_f32 v54, 0x3a000000, v53
    v_mul_f32 v55, 0x41500000, v54
    v_mul_f32 v56, v52, v54
    v_cos_f32 v96, v56
    v_sin_f32 v104, v56
    v_add_f32 v56, v56, v54
    v_cos_f32 v97, v56
    v_sin_f32 v105, v56
    v_add_f32 v56, v56, v54
    v_cos_f32 v98, v56
    v_sin_f32 v106, v56
    v_add_f32 v56, v56, v54
    v_cos_f32 v99, v56
    v_sin_f32 v107, v56
    v_add_f32 v56, v56, v55
    v_cos_f32 v100, v56
    v_sin_f32 v108, v56
    v_add_f32 v56, v56, v54
    v_cos_f32 v101, v56
    v_sin_f32 v109, v56
    v_add_f32 v56, v56, v54
    v_cos_f32 v102, v56
    v_sin_f32 v110, v56
    v_add_f32 v56, v56, v54
    v_cos_f32 v103, v56
    v_sin_f32 v111, v56
    v_mul_f32 v54, 0x3d000000, v51
    v_mul_f32 v56, v52, v54
    v_cos_f32 v152, v56
    v_sin_f32 v156, v56
    v_add_f32 v56, v56, v54
    v_cos_f32 v153, v56
    v_sin_f32 v157, v56
    v_add_f32 v56, v56, v54
    v_cos_f32 v154, v56
    v_sin_f32 v158, v56
    v_add_f32 v56, v56, v54
    v_cos_f32 v155, v56
    v_sin_f32 v159, v56
    v_cvt_pk_bf16_f32 v128, -v156, -v157
    v_cvt_pk_bf16_f32 v129, -v158, -v159
    v_cvt_pk_bf16_f32 v130, v152, v153
    v_cvt_pk_bf16_f32 v131, v154, v155
    v_cvt_pk_bf16_f32 v132, v156, v157
    v_cvt_pk_bf16_f32 v133, v158, v159
    v_xor_b32 v134, v61, v128
    v_xor_b32 v135, v61, v129
    v_xor_b32 v136, v61, v130
    v_xor_b32 v137, v61, v131
    v_xor_b32 v138, v61, v132
    v_xor_b32 v139, v61, v133
    v_xor_b32 v140, 0x80000000, v128
    v_xor_b32 v141, 0x80000000, v129
    v_xor_b32 v142, 0x80000000, v130
    v_xor_b32 v143, 0x80000000, v131
    v_xor_b32 v144, 0x80000000, v132
    v_xor_b32 v145, 0x80000000, v133
    v_xor_b32 v146, 0x80000000, v134
    v_xor_b32 v147, 0x80000000, v135
    v_xor_b32 v148, 0x80000000, v136
    v_xor_b32 v149, 0x80000000, v137
    v_xor_b32 v150, 0x80000000, v138
    v_xor_b32 v151, 0x80000000, v139
    s_cmp_eq_u32 s2, 0
    s_mov_b32 s21, 0x36000000
    s_cselect_b32 s21, 0x34800000, s21
    s_lshl_b32 s28, s3, 4
    v_cvt_f32_u32 v62, s28
    v_add_f32 v62, v62, v52
    v_mul_f32 v54, 0x3a000000, v51
    v_mul_f32 v56, v62, v54
    v_cos_f32 v160, v56
    v_sin_f32 v168, v56
    v_add_f32 v56, v56, v54
    v_cos_f32 v161, v56
    v_sin_f32 v169, v56
    v_add_f32 v56, v56, v54
    v_cos_f32 v162, v56
    v_sin_f32 v170, v56
    v_add_f32 v56, v56, v54
    v_cos_f32 v163, v56
    v_sin_f32 v171, v56
    v_add_f32 v54, 0x3c000000, v54
    v_mul_f32 v56, v62, v54
    v_cos_f32 v164, v56
    v_sin_f32 v172, v56
    v_add_f32 v56, v56, v54
    v_cos_f32 v165, v56
    v_sin_f32 v173, v56
    v_add_f32 v56, v56, v54
    v_cos_f32 v166, v56
    v_sin_f32 v174, v56
    v_add_f32 v56, v56, v54
    v_cos_f32 v167, v56
    v_sin_f32 v175, v56
    v_mul_f32 v160, s21, v160
    v_mul_f32 v168, s21, v168
    v_mul_f32 v161, s21, v161
    v_mul_f32 v169, s21, v169
    v_mul_f32 v162, s21, v162
    v_mul_f32 v170, s21, v170
    v_mul_f32 v163, s21, v163
    v_mul_f32 v171, s21, v171
    v_mul_f32 v164, s21, v164
    v_mul_f32 v172, s21, v172
    v_mul_f32 v165, s21, v165
    v_mul_f32 v173, s21, v173
    v_mul_f32 v166, s21, v166
    v_mul_f32 v174, s21, v174
    v_mul_f32 v167, s21, v167
    v_mul_f32 v175, s21, v175
    v_lshrrev_b32 v2, 1, v1
    v_lshlrev_b32 v2, 13, v2
    v_and_b32 v6, 1, v1
    v_lshl_add_u32 v6, v6, 4, v2
    s_cmp_lt_u32 s2, 192
    s_cbranch_scc1 adaLN_cond__spectral_gfnet__glu_gated_bilinear__prompt_kernel_NC231
    v_mul_f32 v63, 0xbfb8aa3b, v28
    v_exp_f32 v63, v63
    s_nop 0
    v_add_f32 v63, 1.0, v63
    v_rcp_f32 v63, v63
    s_nop 0
    v_mul_f32 v63, v28, v63
    v_cvt_pk_bf16_f32 v63, v63, v63
    v_and_b32 v198, 0xffff0000, v63
    v_mul_f32 v63, 0xbfb8aa3b, v29
    v_exp_f32 v63, v63
    s_nop 0
    v_add_f32 v63, 1.0, v63
    v_rcp_f32 v63, v63
    s_nop 0
    v_mul_f32 v63, v29, v63
    v_cvt_pk_bf16_f32 v63, v63, v63
    v_and_b32 v199, 0xffff0000, v63
    s_nop 0
    v_mov_b32_dpp v176, v198 quad_perm:[0,0,0,0] row_mask:0xf bank_mask:0xf
    v_mov_b32_dpp v177, v198 quad_perm:[1,1,1,1] row_mask:0xf bank_mask:0xf
    v_mov_b32_dpp v178, v198 quad_perm:[2,2,2,2] row_mask:0xf bank_mask:0xf
    v_mov_b32_dpp v179, v198 quad_perm:[3,3,3,3] row_mask:0xf bank_mask:0xf
    v_mov_b32_dpp v180, v199 quad_perm:[0,0,0,0] row_mask:0xf bank_mask:0xf
    v_mov_b32_dpp v181, v199 quad_perm:[1,1,1,1] row_mask:0xf bank_mask:0xf
    v_mov_b32_dpp v182, v199 quad_perm:[2,2,2,2] row_mask:0xf bank_mask:0xf
    v_mov_b32_dpp v183, v199 quad_perm:[3,3,3,3] row_mask:0xf bank_mask:0xf
    v_accvgpr_read_b32 v63, a0
    v_lshlrev_b32 v192, 16, v63
    v_and_b32 v193, 0xffff0000, v63
    v_mul_f32 v184, v176, v192
    v_mul_f32 v185, v176, v193
    v_accvgpr_read_b32 v63, a1
    v_lshlrev_b32 v192, 16, v63
    v_and_b32 v193, 0xffff0000, v63
    v_mul_f32 v186, v176, v192
    v_mul_f32 v187, v176, v193
    v_accvgpr_read_b32 v63, a2
    v_lshlrev_b32 v192, 16, v63
    v_and_b32 v193, 0xffff0000, v63
    v_mul_f32 v188, v176, v192
    v_mul_f32 v189, v176, v193
    v_accvgpr_read_b32 v63, a3
    v_lshlrev_b32 v192, 16, v63
    v_and_b32 v193, 0xffff0000, v63
    v_mul_f32 v190, v176, v192
    v_mul_f32 v191, v176, v193
    v_accvgpr_read_b32 v63, a4
    v_lshlrev_b32 v192, 16, v63
    v_and_b32 v193, 0xffff0000, v63
    v_fmac_f32 v184, v177, v192
    v_fmac_f32 v185, v177, v193
    v_accvgpr_read_b32 v63, a5
    v_lshlrev_b32 v192, 16, v63
    v_and_b32 v193, 0xffff0000, v63
    v_fmac_f32 v186, v177, v192
    v_fmac_f32 v187, v177, v193
    v_accvgpr_read_b32 v63, a6
    v_lshlrev_b32 v192, 16, v63
    v_and_b32 v193, 0xffff0000, v63
    v_fmac_f32 v188, v177, v192
    v_fmac_f32 v189, v177, v193
    v_accvgpr_read_b32 v63, a7
    v_lshlrev_b32 v192, 16, v63
    v_and_b32 v193, 0xffff0000, v63
    v_fmac_f32 v190, v177, v192
    v_fmac_f32 v191, v177, v193
    v_accvgpr_read_b32 v63, a8
    v_lshlrev_b32 v192, 16, v63
    v_and_b32 v193, 0xffff0000, v63
    v_fmac_f32 v184, v178, v192
    v_fmac_f32 v185, v178, v193
    v_accvgpr_read_b32 v63, a9
    v_lshlrev_b32 v192, 16, v63
    v_and_b32 v193, 0xffff0000, v63
    v_fmac_f32 v186, v178, v192
    v_fmac_f32 v187, v178, v193
    v_accvgpr_read_b32 v63, a10
    v_lshlrev_b32 v192, 16, v63
    v_and_b32 v193, 0xffff0000, v63
    v_fmac_f32 v188, v178, v192
    v_fmac_f32 v189, v178, v193
    v_accvgpr_read_b32 v63, a11
    v_lshlrev_b32 v192, 16, v63
    v_and_b32 v193, 0xffff0000, v63
    v_fmac_f32 v190, v178, v192
    v_fmac_f32 v191, v178, v193
    v_accvgpr_read_b32 v63, a12
    v_lshlrev_b32 v192, 16, v63
    v_and_b32 v193, 0xffff0000, v63
    v_fmac_f32 v184, v179, v192
    v_fmac_f32 v185, v179, v193
    v_accvgpr_read_b32 v63, a13
    v_lshlrev_b32 v192, 16, v63
    v_and_b32 v193, 0xffff0000, v63
    v_fmac_f32 v186, v179, v192
    v_fmac_f32 v187, v179, v193
    v_accvgpr_read_b32 v63, a14
    v_lshlrev_b32 v192, 16, v63
    v_and_b32 v193, 0xffff0000, v63
    v_fmac_f32 v188, v179, v192
    v_fmac_f32 v189, v179, v193
    v_accvgpr_read_b32 v63, a15
    v_lshlrev_b32 v192, 16, v63
    v_and_b32 v193, 0xffff0000, v63
    v_fmac_f32 v190, v179, v192
    v_fmac_f32 v191, v179, v193
    v_accvgpr_read_b32 v63, a16
    v_lshlrev_b32 v192, 16, v63
    v_and_b32 v193, 0xffff0000, v63
    v_fmac_f32 v184, v180, v192
    v_fmac_f32 v185, v180, v193
    v_accvgpr_read_b32 v63, a17
    v_lshlrev_b32 v192, 16, v63
    v_and_b32 v193, 0xffff0000, v63
    v_fmac_f32 v186, v180, v192
    v_fmac_f32 v187, v180, v193
    v_accvgpr_read_b32 v63, a18
    v_lshlrev_b32 v192, 16, v63
    v_and_b32 v193, 0xffff0000, v63
    v_fmac_f32 v188, v180, v192
    v_fmac_f32 v189, v180, v193
    v_accvgpr_read_b32 v63, a19
    v_lshlrev_b32 v192, 16, v63
    v_and_b32 v193, 0xffff0000, v63
    v_fmac_f32 v190, v180, v192
    v_fmac_f32 v191, v180, v193
    v_accvgpr_read_b32 v63, a20
    v_lshlrev_b32 v192, 16, v63
    v_and_b32 v193, 0xffff0000, v63
    v_fmac_f32 v184, v181, v192
    v_fmac_f32 v185, v181, v193
    v_accvgpr_read_b32 v63, a21
    v_lshlrev_b32 v192, 16, v63
    v_and_b32 v193, 0xffff0000, v63
    v_fmac_f32 v186, v181, v192
    v_fmac_f32 v187, v181, v193
    v_accvgpr_read_b32 v63, a22
    v_lshlrev_b32 v192, 16, v63
    v_and_b32 v193, 0xffff0000, v63
    v_fmac_f32 v188, v181, v192
    v_fmac_f32 v189, v181, v193
    v_accvgpr_read_b32 v63, a23
    v_lshlrev_b32 v192, 16, v63
    v_and_b32 v193, 0xffff0000, v63
    v_fmac_f32 v190, v181, v192
    v_fmac_f32 v191, v181, v193
    v_accvgpr_read_b32 v63, a24
    v_lshlrev_b32 v192, 16, v63
    v_and_b32 v193, 0xffff0000, v63
    v_fmac_f32 v184, v182, v192
    v_fmac_f32 v185, v182, v193
    v_accvgpr_read_b32 v63, a25
    v_lshlrev_b32 v192, 16, v63
    v_and_b32 v193, 0xffff0000, v63
    v_fmac_f32 v186, v182, v192
    v_fmac_f32 v187, v182, v193
    v_accvgpr_read_b32 v63, a26
    v_lshlrev_b32 v192, 16, v63
    v_and_b32 v193, 0xffff0000, v63
    v_fmac_f32 v188, v182, v192
    v_fmac_f32 v189, v182, v193
    v_accvgpr_read_b32 v63, a27
    v_lshlrev_b32 v192, 16, v63
    v_and_b32 v193, 0xffff0000, v63
    v_fmac_f32 v190, v182, v192
    v_fmac_f32 v191, v182, v193
    v_accvgpr_read_b32 v63, a28
    v_lshlrev_b32 v192, 16, v63
    v_and_b32 v193, 0xffff0000, v63
    v_fmac_f32 v184, v183, v192
    v_fmac_f32 v185, v183, v193
    v_accvgpr_read_b32 v63, a29
    v_lshlrev_b32 v192, 16, v63
    v_and_b32 v193, 0xffff0000, v63
    v_fmac_f32 v186, v183, v192
    v_fmac_f32 v187, v183, v193
    v_accvgpr_read_b32 v63, a30
    v_lshlrev_b32 v192, 16, v63
    v_and_b32 v193, 0xffff0000, v63
    v_fmac_f32 v188, v183, v192
    v_fmac_f32 v189, v183, v193
    v_accvgpr_read_b32 v63, a31
    v_lshlrev_b32 v192, 16, v63
    v_and_b32 v193, 0xffff0000, v63
    v_fmac_f32 v190, v183, v192
    v_fmac_f32 v191, v183, v193
    v_permlane32_swap_b32 v184, v185
    v_permlane32_swap_b32 v186, v187
    v_permlane32_swap_b32 v188, v189
    v_permlane32_swap_b32 v190, v191
    v_add_f32 v184, v184, v185
    v_add_f32 v186, v186, v187
    v_add_f32 v188, v188, v189
    v_add_f32 v190, v190, v191
    v_permlane16_swap_b32 v184, v186
    s_nop 0
    v_permlane16_swap_b32 v188, v190
    v_add_f32 v184, v184, v186
    v_add_f32 v188, v188, v190
    s_nop 0
    v_add_f32_dpp v184, v184, v184 row_ror:8 row_mask:0xf bank_mask:0xf
    v_add_f32_dpp v188, v188, v188 row_ror:8 row_mask:0xf bank_mask:0xf
    v_cndmask_b32 v184, v184, v188, s[62:63]
    ds_write_b32 v26, v184 offset:0
    s_waitcnt lgkmcnt(0)
    s_barrier
    s_cmp_lg_u32 s3, 0
    s_cbranch_scc1 adaLN_cond__spectral_gfnet__glu_gated_bilinear__prompt_kernel_NC231
    v_lshlrev_b32 v63, 2, v1
    ds_read_b32 v194, v63 offset:0
    ds_read_b32 v195, v63 offset:256
    ds_read_b32 v196, v63 offset:512
    ds_read_b32 v197, v63 offset:768
    s_waitcnt lgkmcnt(0)
    v_add_f32 v194, v194, v195
    v_add_f32 v196, v196, v197
    v_add_f32 v194, v194, v196
    buffer_store_dword v194, v63, s[36:39], s41 offen sc1
adaLN_cond__spectral_gfnet__glu_gated_bilinear__prompt_kernel_NC231:
    s_cmp_lg_u32 s3, 0
    s_cbranch_scc1 adaLN_cond__spectral_gfnet__glu_gated_bilinear__prompt_kernel_POLLAX34
    v_lshlrev_b32 v5, 4, v1
    s_and_b32 s29, s2, 7
    s_lshl_b32 s29, s29, 10
    s_add_u32 s29, s29, 0x1312000
    s_mov_b32 s21, 0
adaLN_cond__spectral_gfnet__glu_gated_bilinear__prompt_kernel_POLLA32:
    buffer_load_dwordx4 v[28:31], v5, s[36:39], s29 offen sc1
    s_add_u32 s21, s21, 1
    s_waitcnt vmcnt(0)
    v_xor_b32 v28, s34, v28
    v_xor_b32 v29, s34, v29
    v_xor_b32 v30, s34, v30
    v_xor_b32 v31, s34, v31
    v_or3_b32 v7, v28, v29, v30
    v_or_b32 v7, v7, v31
    v_cmp_ne_u32 vcc, 0, v7
    s_nop 0
    s_cbranch_vccz adaLN_cond__spectral_gfnet__glu_gated_bilinear__prompt_kernel_POLLAD33
    s_cmp_lt_u32 s21, 0x20000
    s_cbranch_scc1 adaLN_cond__spectral_gfnet__glu_gated_bilinear__prompt_kernel_POLLA32
adaLN_cond__spectral_gfnet__glu_gated_bilinear__prompt_kernel_POLLAD33:
adaLN_cond__spectral_gfnet__glu_gated_bilinear__prompt_kernel_POLLAX34:
    s_barrier
    s_cmp_lg_u32 s2, 0
    s_cbranch_scc1 adaLN_cond__spectral_gfnet__glu_gated_bilinear__prompt_kernel_NOWN30
    buffer_load_dwordx4 v[120:123], v3, s[36:39], s9 offen offset:0 sc1
    buffer_load_dwordx4 v[124:127], v3, s[36:39], s9 offen offset:1024 sc1
adaLN_cond__spectral_gfnet__glu_gated_bilinear__prompt_kernel_NOWN30:
    buffer_load_dwordx4 a[84:87], v6, s[36:39], s7 offen sc1
    s_add_u32 s7, s7, 0x40000
    buffer_load_dwordx4 a[88:91], v6, s[36:39], s7 offen sc1
    buffer_load_dwordx4 v[112:115], v6, s[36:39], s8 offen sc1
    s_add_u32 s8, s8, 0x40000
    buffer_load_dwordx4 v[116:119], v6, s[36:39], s8 offen sc1
    s_lshl_b32 s28, s3, 11
    v_add_u32 v2, s28, v3
    s_mov_b32 s44, s4
    s_mov_b32 s45, s5
    s_mov_b32 s46, 0x200000
    s_mov_b32 s47, 0x00020000
    s_mov_b32 s19, 0x218000
    s_mov_b32 s20, 0x21a000
    s_and_b32 s18, s3, 2
    s_cmp_eq_u32 s18, 0
    s_cselect_b32 s48, s12, s14
    s_cselect_b32 s49, s13, s15
    buffer_load_dword a32, v50, s[48:51], 0 offen
    s_waitcnt vmcnt(3)
    ds_write_b128 v2, a[84:87] offset:28928
    ds_write_b128 v2, a[88:91] offset:29952
    s_waitcnt lgkmcnt(0)
    s_barrier
    ds_read_b128 a[36:39], v3 offset:28928
    ds_read_b128 a[40:43], v3 offset:29952
    ds_read_b128 a[44:47], v3 offset:30976
    ds_read_b128 a[48:51], v3 offset:32000
    ds_read_b128 a[52:55], v3 offset:33024
    ds_read_b128 a[56:59], v3 offset:34048
    ds_read_b128 a[60:63], v3 offset:35072
    ds_read_b128 a[64:67], v3 offset:36096
    s_cmp_eq_u32 s2, 0
    s_cbranch_scc1 adaLN_cond__spectral_gfnet__glu_gated_bilinear__prompt_kernel_PQ35
adaLN_cond__spectral_gfnet__glu_gated_bilinear__prompt_kernel_PQR36:
    s_waitcnt lgkmcnt(7)
    v_mfma_f32_16x16x32_bf16 v[28:31], a[36:39], v[64:67], 0
    v_mfma_f32_16x16x32_bf16 v[176:179], a[36:39], v[80:83], 0
    s_waitcnt lgkmcnt(6)
    v_mfma_f32_16x16x32_bf16 v[28:31], a[40:43], v[68:71], v[28:31]
    v_mfma_f32_16x16x32_bf16 v[176:179], a[40:43], v[84:87], v[176:179]
    s_waitcnt lgkmcnt(5)
    v_mfma_f32_16x16x32_bf16 v[28:31], a[44:47], v[72:75], v[28:31]
    v_mfma_f32_16x16x32_bf16 v[176:179], a[44:47], v[88:91], v[176:179]
    s_waitcnt lgkmcnt(4)
    v_mfma_f32_16x16x32_bf16 v[28:31], a[48:51], v[76:79], v[28:31]
    v_mfma_f32_16x16x32_bf16 v[176:179], a[48:51], v[92:95], v[176:179]
    s_waitcnt lgkmcnt(0)
    v_mfma_f32_16x16x32_bf16 v[32:35], a[52:55], v[64:67], 0
    v_mfma_f32_16x16x32_bf16 v[180:183], a[52:55], v[80:83], 0
    v_mfma_f32_16x16x32_bf16 v[32:35], a[56:59], v[68:71], v[32:35]
    v_mfma_f32_16x16x32_bf16 v[180:183], a[56:59], v[84:87], v[180:183]
    s_nop 1
    v_mul_f32 v184, v28, v96
    v_mul_f32 v188, v176, v96
    v_mul_f32 v185, v29, v97
    v_mfma_f32_16x16x32_bf16 v[32:35], a[60:63], v[72:75], v[32:35]
    buffer_load_dwordx2 v[36:37], v27, s[44:47], s33 offen offset:0
    v_mul_f32 v189, v177, v97
    v_mul_f32 v186, v30, v98
    v_mul_f32 v190, v178, v98
    v_mfma_f32_16x16x32_bf16 v[180:183], a[60:63], v[88:91], v[180:183]
    buffer_load_dwordx2 v[38:39], v27, s[44:47], s33 offen offset:512
    v_mul_f32 v187, v31, v99
    v_mul_f32 v191, v179, v99
    v_fmac_f32 v184, v176, v104
    v_mfma_f32_16x16x32_bf16 v[32:35], a[64:67], v[76:79], v[32:35]
    buffer_load_dwordx2 v[40:41], v27, s[44:47], s33 offen offset:1024
    v_fma_f32 v188, -v28, v104, v188
    v_fmac_f32 v185, v177, v105
    v_fma_f32 v189, -v29, v105, v189
    v_mfma_f32_16x16x32_bf16 v[180:183], a[64:67], v[92:95], v[180:183]
    buffer_load_dwordx2 v[42:43], v27, s[44:47], s33 offen offset:1536
    v_fmac_f32 v186, v178, v106
    v_fma_f32 v190, -v30, v106, v190
    v_fmac_f32 v187, v179, v107
    v_fma_f32 v191, -v31, v107, v191
    v_cvt_pk_bf16_f32 v192, v184, v185
    v_cvt_pk_bf16_f32 v193, v186, v187
    v_cvt_pk_bf16_f32 v194, v188, v189
    v_cvt_pk_bf16_f32 v195, v190, v191
    s_nop 1
    v_mfma_f32_16x16x32_bf16 v[200:203], v[130:133], v[192:195], 0
    v_mfma_f32_16x16x32_bf16 v[208:211], v[128:131], v[192:195], 0
    v_mfma_f32_16x16x32_bf16 v[204:207], v[142:145], v[192:195], 0
    v_mul_f32 v184, v32, v100
    v_mul_f32 v188, v180, v100
    v_mul_f32 v185, v33, v101
    v_mul_f32 v189, v181, v101
    v_mfma_f32_16x16x32_bf16 v[212:215], v[140:143], v[192:195], 0
    v_mul_f32 v186, v34, v102
    v_mul_f32 v190, v182, v102
    v_mul_f32 v187, v35, v103
    v_mul_f32 v191, v183, v103
    v_fmac_f32 v184, v180, v108
    v_fma_f32 v188, -v32, v108, v188
    v_fmac_f32 v185, v181, v109
    v_fma_f32 v189, -v33, v109, v189
    v_fmac_f32 v186, v182, v110
    v_fma_f32 v190, -v34, v110, v190
    v_fmac_f32 v187, v183, v111
    v_fma_f32 v191, -v35, v111, v191
    v_cvt_pk_bf16_f32 v196, v184, v185
    v_cvt_pk_bf16_f32 v197, v186, v187
    v_cvt_pk_bf16_f32 v198, v188, v189
    v_cvt_pk_bf16_f32 v199, v190, v191
    s_nop 1
    v_mfma_f32_16x16x32_bf16 v[200:203], v[136:139], v[196:199], v[200:203]
    v_mfma_f32_16x16x32_bf16 v[208:211], v[134:137], v[196:199], v[208:211]
    v_mfma_f32_16x16x32_bf16 v[204:207], v[148:151], v[196:199], v[204:207]
    v_mfma_f32_16x16x32_bf16 v[212:215], v[146:149], v[196:199], v[212:215]
    s_waitcnt vmcnt(5)
    s_cmp_eq_u32 s2, 0
    s_cbranch_scc1 adaLN_cond__spectral_gfnet__glu_gated_bilinear__prompt_kernel_FS37
    v_lshlrev_b32 v152, 16, v112
    v_and_b32 v156, 0xffff0000, v112
    v_lshlrev_b32 v153, 16, v113
    v_and_b32 v157, 0xffff0000, v113
    v_lshlrev_b32 v154, 16, v114
    v_and_b32 v158, 0xffff0000, v114
    v_lshlrev_b32 v155, 16, v115
    v_and_b32 v159, 0xffff0000, v115
    v_lshlrev_b32 v96, 16, v116
    v_and_b32 v104, 0xffff0000, v116
    v_lshlrev_b32 v97, 16, v117
    v_and_b32 v105, 0xffff0000, v117
    v_lshlrev_b32 v98, 16, v118
    v_and_b32 v106, 0xffff0000, v118
    v_lshlrev_b32 v99, 16, v119
    v_and_b32 v107, 0xffff0000, v119
    v_mul_f32 v184, v200, v152
    v_mul_f32_e64 v188, -v200, v156
    v_mul_f32 v185, v201, v153
    v_mul_f32_e64 v189, -v201, v157
    v_mul_f32 v186, v202, v154
    v_mul_f32_e64 v190, -v202, v158
    v_mul_f32 v187, v203, v155
    v_mul_f32_e64 v191, -v203, v159
    v_fma_f32 v184, -v208, v156, v184
    v_fma_f32 v188, -v208, v152, v188
    v_fma_f32 v185, -v209, v157, v185
    v_fma_f32 v189, -v209, v153, v189
    v_fma_f32 v186, -v210, v158, v186
    v_fma_f32 v190, -v210, v154, v190
    v_fma_f32 v187, -v211, v159, v187
    v_fma_f32 v191, -v211, v155, v191
    v_cvt_pk_bf16_f32 v216, v184, v185
    v_cvt_pk_bf16_f32 v217, v186, v187
    v_cvt_pk_bf16_f32 v218, v188, v189
    v_cvt_pk_bf16_f32 v219, v190, v191
    s_nop 1
    v_mfma_f32_16x16x32_bf16 v[28:31], v[216:219], v[130:133], 0
    v_mul_f32 v184, v204, v96
    v_mul_f32_e64 v188, -v204, v104
    v_mul_f32 v185, v205, v97
    v_mul_f32_e64 v189, -v205, v105
    v_mfma_f32_16x16x32_bf16 v[176:179], v[216:219], v[128:131], 0
    v_mul_f32 v186, v206, v98
    v_mul_f32_e64 v190, -v206, v106
    v_mul_f32 v187, v207, v99
    v_mul_f32_e64 v191, -v207, v107
    v_mfma_f32_16x16x32_bf16 v[32:35], v[216:219], v[142:145], 0
    v_fma_f32 v184, -v212, v104, v184
    v_fma_f32 v188, -v212, v96, v188
    v_fma_f32 v185, -v213, v105, v185
    v_fma_f32 v189, -v213, v97, v189
    v_mfma_f32_16x16x32_bf16 v[180:183], v[216:219], v[140:143], 0
    v_fma_f32 v186, -v214, v106, v186
    v_fma_f32 v190, -v214, v98, v190
    v_fma_f32 v187, -v215, v107, v187
    v_fma_f32 v191, -v215, v99, v191
    v_cvt_pk_bf16_f32 v220, v184, v185
    v_cvt_pk_bf16_f32 v221, v186, v187
    v_cvt_pk_bf16_f32 v222, v188, v189
    v_cvt_pk_bf16_f32 v223, v190, v191
adaLN_cond__spectral_gfnet__glu_gated_bilinear__prompt_kernel_FJ38:
    s_nop 1
    v_mfma_f32_16x16x32_bf16 v[28:31], v[220:223], v[136:139], v[28:31]
    v_mfma_f32_16x16x32_bf16 v[176:179], v[220:223], v[134:137], v[176:179]
    v_mfma_f32_16x16x32_bf16 v[32:35], v[220:223], v[148:151], v[32:35]
    v_mfma_f32_16x16x32_bf16 v[180:183], v[220:223], v[146:149], v[180:183]
    s_nop 4
    v_mul_f32 v184, v28, v160
    v_mul_f32 v188, v176, v160
    v_mul_f32 v185, v29, v161
    v_mul_f32 v189, v177, v161
    v_mul_f32 v186, v30, v162
    v_mul_f32 v190, v178, v162
    v_mul_f32 v187, v31, v163
    v_mul_f32 v191, v179, v163
    v_fmac_f32 v184, v176, v168
    v_fma_f32 v188, -v28, v168, v188
    v_fmac_f32 v185, v177, v169
    v_fma_f32 v189, -v29, v169, v189
    v_fmac_f32 v186, v178, v170
    v_fma_f32 v190, -v30, v170, v190
    v_fmac_f32 v187, v179, v171
    v_fma_f32 v191, -v31, v171, v191
    v_cvt_pk_bf16_f32 v192, v184, v188
    v_cvt_pk_bf16_f32 v193, v185, v189
    v_cvt_pk_bf16_f32 v194, v186, v190
    v_cvt_pk_bf16_f32 v195, v187, v191
    ds_write_b128 v45, v[192:195] offset:0
    v_mul_f32 v184, v32, v164
    v_mul_f32 v188, v180, v164
    v_mul_f32 v185, v33, v165
    v_mul_f32 v189, v181, v165
    v_mul_f32 v186, v34, v166
    v_mul_f32 v190, v182, v166
    v_mul_f32 v187, v35, v167
    v_mul_f32 v191, v183, v167
    v_fmac_f32 v184, v180, v172
    v_fma_f32 v188, -v32, v172, v188
    v_fmac_f32 v185, v181, v173
    v_fma_f32 v189, -v33, v173, v189
    v_fmac_f32 v186, v182, v174
    v_fma_f32 v190, -v34, v174, v190
    v_fmac_f32 v187, v183, v175
    v_fma_f32 v191, -v35, v175, v191
    v_cvt_pk_bf16_f32 v196, v184, v188
    v_cvt_pk_bf16_f32 v197, v185, v189
    v_cvt_pk_bf16_f32 v198, v186, v190
    v_cvt_pk_bf16_f32 v199, v187, v191
    ds_write_b128 v45, v[196:199] offset:4096
    s_waitcnt lgkmcnt(0)
    s_barrier
    ds_read_b128 a[36:39], v46 offset:0
    ds_read_b128 a[40:43], v46 offset:1024
    ds_read_b128 a[44:47], v46 offset:2048
    ds_read_b128 a[48:51], v46 offset:3072
    ds_read_b128 a[52:55], v46 offset:4096
    ds_read_b128 a[56:59], v46 offset:5120
    ds_read_b128 a[60:63], v46 offset:6144
    ds_read_b128 a[64:67], v46 offset:7168
    s_waitcnt lgkmcnt(7)
    v_mfma_f32_16x16x32_bf16 v[200:203], v[64:67], a[36:39], 0
    v_mfma_f32_16x16x32_bf16 v[208:211], v[80:83], a[36:39], 0
    s_waitcnt lgkmcnt(6)
    v_mfma_f32_16x16x32_bf16 v[200:203], v[68:71], a[40:43], v[200:203]
    v_mfma_f32_16x16x32_bf16 v[208:211], v[84:87], a[40:43], v[208:211]
    s_waitcnt lgkmcnt(5)
    v_mfma_f32_16x16x32_bf16 v[200:203], v[72:75], a[44:47], v[200:203]
    v_mfma_f32_16x16x32_bf16 v[208:211], v[88:91], a[44:47], v[208:211]
    s_waitcnt lgkmcnt(4)
    v_mfma_f32_16x16x32_bf16 v[200:203], v[76:79], a[48:51], v[200:203]
    v_mfma_f32_16x16x32_bf16 v[208:211], v[92:95], a[48:51], v[208:211]
    s_waitcnt lgkmcnt(3)
    v_mfma_f32_16x16x32_bf16 v[204:207], v[64:67], a[52:55], 0
    v_mfma_f32_16x16x32_bf16 v[212:215], v[80:83], a[52:55], 0
    s_waitcnt lgkmcnt(2)
    v_mfma_f32_16x16x32_bf16 v[204:207], v[68:71], a[56:59], v[204:207]
    v_mfma_f32_16x16x32_bf16 v[212:215], v[84:87], a[56:59], v[212:215]
    s_waitcnt lgkmcnt(1)
    v_mfma_f32_16x16x32_bf16 v[204:207], v[72:75], a[60:63], v[204:207]
    v_mfma_f32_16x16x32_bf16 v[212:215], v[88:91], a[60:63], v[212:215]
    s_waitcnt lgkmcnt(0)
    v_mfma_f32_16x16x32_bf16 v[204:207], v[76:79], a[64:67], v[204:207]
    v_mfma_f32_16x16x32_bf16 v[212:215], v[92:95], a[64:67], v[212:215]
    v_cvt_pk_bf16_f32 v192, v200, -v208
    v_cvt_pk_bf16_f32 v193, v201, -v209
    v_cvt_pk_bf16_f32 v194, v202, -v210
    v_cvt_pk_bf16_f32 v195, v203, -v211
    buffer_store_dwordx4 v[192:195], v3, s[36:39], s10 offen sc1
    s_nop 2
    v_cvt_pk_bf16_f32 v196, v204, -v212
    v_cvt_pk_bf16_f32 v197, v205, -v213
    v_cvt_pk_bf16_f32 v198, v206, -v214
    v_cvt_pk_bf16_f32 v199, v207, -v215
    buffer_store_dwordx4 v[196:199], v44, s[36:39], s10 offen sc1
    v_and_b32 v188, 3, v1
    v_bfe_u32 v189, v1, 2, 2
    v_lshrrev_b32 v190, 4, v1
    v_lshrrev_b32 v2, 1, v190
    v_lshl_add_u32 v2, v2, 3, v189
    v_lshlrev_b32 v184, 7, v2
    v_and_b32 v2, 1, v190
    v_lshlrev_b32 v2, 1, v2
    v_lshrrev_b32 v191, 1, v188
    v_add_u32 v2, v2, v191
    v_lshrrev_b32 v191, 1, v189
    v_lshlrev_b32 v191, 2, v191
    v_xor_b32 v2, v2, v191
    v_lshl_add_u32 v184, v2, 4, v184
    v_and_b32 v2, 1, v188
    v_lshl_add_u32 v184, v2, 3, v184
    s_lshl_b32 s28, s3, 11
    s_add_u32 s28, s28, 132608
    v_add_u32 v184, s28, v184
    v_xor_b32 v185, 64, v184
    s_cmp_lt_u32 s2, 32
    s_cbranch_scc1 adaLN_cond__spectral_gfnet__glu_gated_bilinear__prompt_kernel_NORL41
    ds_read_b64_tr_b16 v[28:29], v184 offset:0
    ds_read_b64_tr_b16 v[30:31], v184 offset:512
    ds_read_b64_tr_b16 v[32:33], v185 offset:0
    ds_read_b64_tr_b16 v[34:35], v185 offset:512
    s_waitcnt lgkmcnt(0)
    buffer_store_dwordx4 v[28:31], v3, s[36:39], s11 offen sc1
    buffer_store_dwordx4 v[32:35], v3, s[36:39], s11 offen offset:1024 sc1
adaLN_cond__spectral_gfnet__glu_gated_bilinear__prompt_kernel_NORL41:
    s_lshl_b32 s4, s2, 2
    s_add_u32 s4, s4, 0x1310000
    v_mov_b32 v6, s34
    v_lshlrev_b32 v5, 10, v1
    s_waitcnt vmcnt(0)
    s_barrier
    s_cmp_lg_u32 s3, 0
    s_cbranch_scc1 adaLN_cond__spectral_gfnet__glu_gated_bilinear__prompt_kernel_PUBB42
    s_mov_b64 exec, 255
    buffer_store_dword v6, v5, s[36:39], s4 offen sc1
    s_mov_b64 exec, -1
    s_cmp_lg_u32 s2, 1
    s_cbranch_scc1 adaLN_cond__spectral_gfnet__glu_gated_bilinear__prompt_kernel_PUBB42
    s_mov_b32 s4, 0x213f80
    s_mov_b64 exec, 1
    buffer_store_dword v6, v4, s[36:39], s4 offen sc1
    s_mov_b64 exec, -1
adaLN_cond__spectral_gfnet__glu_gated_bilinear__prompt_kernel_PUBB42:
    v_and_b32 v2, 1, v0
    v_lshrrev_b32 v26, 1, v0
    v_lshlrev_b32 v26, 13, v26
    v_lshl_add_u32 v26, v2, 4, v26
    s_lshl_b32 s4, s32, 5
    s_add_u32 s4, s4, 0x430000
    s_add_u32 s5, s4, 0x100000
    s_and_b32 s6, s3, 1
    s_lshr_b32 s7, s3, 1
    s_mul_i32 s28, s7, 114688
    s_mul_i32 s29, s31, 224
    s_add_u32 s28, s28, s29
    s_mul_i32 s16, s6, 14464
    s_mul_i32 s29, s7, 7168
    s_add_u32 s16, s16, s29
    s_mov_b32 s17, 0
    s_mov_b32 s7, 4682
    v_add_u32 v28, 0, v1
    v_mul_u32_u24 v29, s7, v28
    v_lshrrev_b32 v29, 16, v29
    v_mul_u32_u24 v2, 14, v29
    v_sub_u32 v28, v28, v2
    v_mul_u32_u24 v29, 3584, v29
    v_lshl_add_u32 v8, v28, 4, v29
    v_add_u32 v8, s28, v8
    v_add_u32 v28, 64, v1
    v_mul_u32_u24 v29, s7, v28
    v_lshrrev_b32 v29, 16, v29
    v_mul_u32_u24 v2, 14, v29
    v_sub_u32 v28, v28, v2
    v_mul_u32_u24 v29, 3584, v29
    v_lshl_add_u32 v9, v28, 4, v29
    v_add_u32 v9, s28, v9
    v_subrev_u32 v9, 1024, v9
    v_add_u32 v28, 128, v1
    v_mul_u32_u24 v29, s7, v28
    v_lshrrev_b32 v29, 16, v29
    v_mul_u32_u24 v2, 14, v29
    v_sub_u32 v28, v28, v2
    v_mul_u32_u24 v29, 3584, v29
    v_lshl_add_u32 v10, v28, 4, v29
    v_add_u32 v10, s28, v10
    v_subrev_u32 v10, 2048, v10
    v_add_u32 v28, 192, v1
    v_mul_u32_u24 v29, s7, v28
    v_lshrrev_b32 v29, 16, v29
    v_mul_u32_u24 v2, 14, v29
    v_sub_u32 v28, v28, v2
    v_mul_u32_u24 v29, 3584, v29
    v_lshl_add_u32 v11, v28, 4, v29
    v_add_u32 v11, s28, v11
    v_subrev_u32 v11, 3072, v11
    v_add_u32 v28, 256, v1
    v_mul_u32_u24 v29, s7, v28
    v_lshrrev_b32 v29, 16, v29
    v_mul_u32_u24 v2, 14, v29
    v_sub_u32 v28, v28, v2
    v_mul_u32_u24 v29, 3584, v29
    v_lshl_add_u32 v12, v28, 4, v29
    v_add_u32 v12, s28, v12
    v_add_u32 v28, 320, v1
    v_mul_u32_u24 v29, s7, v28
    v_lshrrev_b32 v29, 16, v29
    v_mul_u32_u24 v2, 14, v29
    v_sub_u32 v28, v28, v2
    v_mul_u32_u24 v29, 3584, v29
    v_lshl_add_u32 v13, v28, 4, v29
    v_add_u32 v13, s28, v13
    v_subrev_u32 v13, 1024, v13
    v_add_u32 v28, 384, v1
    v_mul_u32_u24 v29, s7, v28
    v_lshrrev_b32 v29, 16, v29
    v_mul_u32_u24 v2, 14, v29
    v_sub_u32 v28, v28, v2
    v_mul_u32_u24 v29, 3584, v29
    v_lshl_add_u32 v14, v28, 4, v29
    v_add_u32 v14, s28, v14
    v_subrev_u32 v14, 2048, v14
    s_cmp_eq_u32 s6, 0
    s_cselect_b32 s8, s12, s14
    s_cselect_b32 s9, s13, s15
    s_mov_b32 s10, 1835008
    s_mov_b32 s11, 0x00020000
    s_add_u32 m0, s16, 0
    s_nop 0
    buffer_load_dwordx4 v8, s[8:11], s17 offen offset:0 lds
    buffer_load_dwordx4 v9, s[8:11], s17 offen offset:1024 lds
    buffer_load_dwordx4 v10, s[8:11], s17 offen offset:2048 lds
    buffer_load_dwordx4 v11, s[8:11], s17 offen offset:3072 lds
    s_add_u32 m0, s16, 4096
    s_nop 0
    buffer_load_dwordx4 v12, s[8:11], s17 offen offset:0 lds
    buffer_load_dwordx4 v13, s[8:11], s17 offen offset:1024 lds
    buffer_load_dwordx4 v14, s[8:11], s17 offen offset:2048 lds
    s_add_u32 s17, s17, 229376
    s_add_u32 m0, s16, 28928
    s_nop 0
    buffer_load_dwordx4 v8, s[8:11], s17 offen offset:0 lds
    buffer_load_dwordx4 v9, s[8:11], s17 offen offset:1024 lds
    buffer_load_dwordx4 v10, s[8:11], s17 offen offset:2048 lds
    buffer_load_dwordx4 v11, s[8:11], s17 offen offset:3072 lds
    s_add_u32 m0, s16, 33024
    s_nop 0
    buffer_load_dwordx4 v12, s[8:11], s17 offen offset:0 lds
    buffer_load_dwordx4 v13, s[8:11], s17 offen offset:1024 lds
    buffer_load_dwordx4 v14, s[8:11], s17 offen offset:2048 lds
    s_add_u32 s17, s17, 229376
    s_add_u32 m0, s16, 57856
    s_nop 0
    buffer_load_dwordx4 v8, s[8:11], s17 offen offset:0 lds
    buffer_load_dwordx4 v9, s[8:11], s17 offen offset:1024 lds
    buffer_load_dwordx4 v10, s[8:11], s17 offen offset:2048 lds
    buffer_load_dwordx4 v11, s[8:11], s17 offen offset:3072 lds
    s_add_u32 m0, s16, 61952
    s_nop 0
    buffer_load_dwordx4 v12, s[8:11], s17 offen offset:0 lds
    buffer_load_dwordx4 v13, s[8:11], s17 offen offset:1024 lds
    buffer_load_dwordx4 v14, s[8:11], s17 offen offset:2048 lds
    s_add_u32 s17, s17, 229376
    v_bfe_u32 v2, v0, 5, 1
    v_lshlrev_b32 v52, 10, v2
    v_bfe_u32 v2, v0, 1, 4
    v_lshl_add_u32 v52, v2, 4, v52
    v_and_b32 v2, 1, v0
    v_lshl_add_u32 v52, v2, 9, v52
    v_add_u32 v53, 256, v52
    v_lshlrev_b32 v2, 5, v1
    s_cmp_eq_u32 s3, 3
    s_cselect_b64 vcc, -1, 0
    v_cndmask_b32 v52, v52, v2, vcc
    v_add_u32 v2, 16, v2
    v_cndmask_b32 v53, v53, v2, vcc
    s_lshl_b32 s28, s3, 11
    s_add_u32 s28, s28, 144640
    v_add_u32 v52, s28, v52
    v_add_u32 v53, s28, v53
    s_cmp_eq_u32 s3, 2
    s_cselect_b32 s6, 1.0, 0
    v_cvt_f32_u32 v54, v24
    v_cvt_f32_u32 v55, v25
    v_and_b32 v2, 1, v24
    v_mul_u32_u24 v62, 0x8000, v2
    v_lshl_or_b32 v62, v62, 16, v62
    v_mul_f32 v56, 0x3d800000, v54
    v_add_f32 v57, v55, v55
    v_mul_f32 v57, v57, v56
    v_cos_f32 v58, v57
    v_sin_f32 v59, v57
    v_add_f32 v57, v57, v56
    v_cvt_pk_bf16_f32 v64, v58, -v59
    v_cvt_pk_bf16_f32 v66, v59, v58
    v_cos_f32 v58, v57
    v_sin_f32 v59, v57
    s_nop 0
    v_cvt_pk_bf16_f32 v65, v58, -v59
    v_cvt_pk_bf16_f32 v67, v59, v58
    v_mul_f32 v84, 4.0, v55
    v_mul_f32 v56, 0x3b000000, v54
    v_mul_f32 v63, 0x41500000, v56
    v_mul_f32 v57, v84, v56
    v_cos_f32 v68, v57
    v_sin_f32 v76, v57
    v_add_f32 v57, v57, v56
    v_cos_f32 v69, v57
    v_sin_f32 v77, v57
    v_add_f32 v57, v57, v56
    v_cos_f32 v70, v57
    v_sin_f32 v78, v57
    v_add_f32 v57, v57, v56
    v_cos_f32 v71, v57
    v_sin_f32 v79, v57
    v_add_f32 v57, v57, v63
    v_cos_f32 v72, v57
    v_sin_f32 v80, v57
    v_add_f32 v57, v57, v56
    v_cos_f32 v73, v57
    v_sin_f32 v81, v57
    v_add_f32 v57, v57, v56
    v_cos_f32 v74, v57
    v_sin_f32 v82, v57
    v_add_f32 v57, v57, v56
    v_cos_f32 v75, v57
    v_sin_f32 v83, v57
    v_mul_f32 v56, 0x3d000000, v54
    v_mul_f32 v57, v84, v56
    v_cos_f32 v112, v57
    v_sin_f32 v116, v57
    v_add_f32 v57, v57, v56
    v_cos_f32 v113, v57
    v_sin_f32 v117, v57
    v_add_f32 v57, v57, v56
    v_cos_f32 v114, v57
    v_sin_f32 v118, v57
    v_add_f32 v57, v57, v56
    v_cos_f32 v115, v57
    v_sin_f32 v119, v57
    v_cvt_pk_bf16_f32 v96, v112, v113
    v_cvt_pk_bf16_f32 v97, v114, v115
    v_cvt_pk_bf16_f32 v98, -v116, -v117
    v_cvt_pk_bf16_f32 v99, -v118, -v119
    v_xor_b32 v100, v62, v96
    v_xor_b32 v101, v62, v97
    v_xor_b32 v102, v62, v98
    v_xor_b32 v103, v62, v99
    v_xor_b32 v104, 0x80000000, v96
    v_xor_b32 v105, 0x80000000, v97
    v_xor_b32 v106, 0x80000000, v98
    v_xor_b32 v107, 0x80000000, v99
    v_xor_b32 v108, 0x80000000, v100
    v_xor_b32 v109, 0x80000000, v101
    v_xor_b32 v110, 0x80000000, v102
    v_xor_b32 v111, 0x80000000, v103
    v_lshlrev_b32 v2, 31, v24
    v_or_b32 v2, 1.0, v2
    v_cmp_eq_u32 vcc, 0, v25
    s_nop 1
    v_cndmask_b32 v85, 0, v2, vcc
    v_and_b32 v2, 1, v0
    v_mul_u32_u24 v120, 4160, v2
    v_lshrrev_b32 v2, 1, v0
    v_lshl_add_u32 v120, v2, 2, v120
    v_add_u32 v120, 115712, v120
    s_mul_i32 s28, s3, 1040
    s_add_u32 s28, s28, 115712
    v_lshlrev_b32 v121, 8, v25
    v_lshl_add_u32 v121, v24, 2, v121
    v_add_u32 v121, s28, v121
    s_lshl_b32 s28, s3, 4
    s_add_u32 s28, s28, 124032
    v_lshrrev_b32 v2, 1, v24
    v_mul_u32_u24 v122, 528, v2
    v_lshl_add_u32 v122, v25, 7, v122
    v_and_b32 v2, 1, v24
    v_lshl_add_u32 v122, v2, 3, v122
    v_add_u32 v122, s28, v122
    v_lshrrev_b32 v2, 5, v0
    v_mul_u32_u24 v123, 528, v2
    v_lshlrev_b32 v124, 10, v2
    v_and_b32 v2, 31, v0
    v_lshl_add_u32 v123, v2, 4, v123
    v_add_u32 v123, 124032, v123
    v_bfe_u32 v2, v0, 3, 2
    v_lshl_add_u32 v124, v2, 8, v124
    v_and_b32 v2, 7, v0
    v_lshl_add_u32 v124, v2, 4, v124
    s_lshr_b32 s7, s32, 1
    s_lshl_b32 s7, s7, 14
    s_and_b32 s29, s32, 1
    s_lshl_b32 s29, s29, 7
    s_add_u32 s7, s7, s29
    s_add_u32 s7, s7, 0x840000
    s_lshl_b32 s12, s32, 3
    s_add_u32 s12, s12, s3
    s_lshl_b32 s12, s12, 10
    s_add_u32 s12, s12, 0x640000
    s_lshl_b32 s28, s3, 11
    s_add_u32 s28, s28, 132736
    v_add_u32 v125, s28, v27
    v_add_u32 v126, s28, v3
    v_add_u32 v127, 144640, v3
    s_mul_i32 s28, s3, 1040
    s_add_u32 s28, s28, 115712
    v_mov_b32 v128, s28
    s_and_b32 s28, s2, 7
    s_lshr_b32 s29, s2, 3
    s_lshl_b32 s13, s28, 2
    s_and_b32 s28, s29, 3
    s_add_u32 s13, s13, s28
    s_lshr_b32 s14, s29, 2
    s_mul_i32 s15, s14, 229376
    s_mul_i32 s28, s3, 57344
    s_add_u32 s15, s15, s28
    s_add_u32 s15, s15, 0x1140000
    s_cmp_lg_u32 s3, 0
    s_cbranch_scc1 adaLN_cond__spectral_gfnet__glu_gated_bilinear__prompt_kernel_POLLYX45
    v_lshlrev_b32 v5, 4, v1
    s_and_b32 s29, s2, 7
    s_lshl_b32 s29, s29, 10
    s_add_u32 s29, s29, 0x1310000
    s_mov_b32 s18, 0
adaLN_cond__spectral_gfnet__glu_gated_bilinear__prompt_kernel_POLLY43:
    buffer_load_dwordx4 v[88:91], v5, s[36:39], s29 offen sc1
    s_add_u32 s18, s18, 1
    s_waitcnt vmcnt(0)
    v_xor_b32 v88, s34, v88
    v_xor_b32 v89, s34, v89
    v_xor_b32 v90, s34, v90
    v_xor_b32 v91, s34, v91
    v_or3_b32 v7, v88, v89, v90
    v_or_b32 v7, v7, v91
    v_cmp_ne_u32 vcc, 0, v7
    s_nop 0
    s_cbranch_vccz adaLN_cond__spectral_gfnet__glu_gated_bilinear__prompt_kernel_POLLYD44
    s_cmp_lt_u32 s18, 0x20000
    s_cbranch_scc1 adaLN_cond__spectral_gfnet__glu_gated_bilinear__prompt_kernel_POLLY43
adaLN_cond__spectral_gfnet__glu_gated_bilinear__prompt_kernel_POLLYD44:
adaLN_cond__spectral_gfnet__glu_gated_bilinear__prompt_kernel_POLLYX45:
    s_waitcnt lgkmcnt(0)
    s_barrier
    v_lshlrev_b32 v129, 5, v0
    s_mov_b32 s28, 0x218000
    buffer_load_dwordx4 a[68:71], v129, s[36:39], s28 offen sc1
    buffer_load_dwordx4 a[72:75], v129, s[36:39], s28 offen offset:16 sc1
    s_mov_b32 s28, 0x21a000
    buffer_load_dwordx4 a[76:79], v129, s[36:39], s28 offen sc1
    buffer_load_dwordx4 a[80:83], v129, s[36:39], s28 offen offset:16 sc1
    buffer_load_dwordx4 v[88:91], v26, s[36:39], s4 offen sc1
    buffer_load_dwordx4 v[92:95], v26, s[36:39], s5 offen sc1
    s_waitcnt vmcnt(2)
    v_accvgpr_read_b32 v28, a68
    v_accvgpr_read_b32 v29, a69
    v_accvgpr_read_b32 v30, a70
    v_accvgpr_read_b32 v31, a71
    v_accvgpr_read_b32 v32, a72
    v_accvgpr_read_b32 v33, a73
    v_accvgpr_read_b32 v34, a74
    v_accvgpr_read_b32 v35, a75
    v_accvgpr_read_b32 v44, a76
    v_accvgpr_read_b32 v45, a77
    v_accvgpr_read_b32 v46, a78
    v_accvgpr_read_b32 v47, a79
    v_accvgpr_read_b32 v48, a80
    v_accvgpr_read_b32 v49, a81
    v_accvgpr_read_b32 v50, a82
    v_accvgpr_read_b32 v51, a83
    v_add_f32 v28, v28, v44
    v_add_f32 v29, v29, v45
    v_add_f32 v30, v30, v46
    v_add_f32 v31, v31, v47
    v_add_f32 v32, v32, v48
    v_add_f32 v33, v33, v49
    v_add_f32 v34, v34, v50
    v_add_f32 v35, v35, v51
    v_cvt_pk_bf16_f32 v44, v28, v29
    v_cvt_pk_bf16_f32 v45, v30, v31
    v_cvt_pk_bf16_f32 v46, v32, v33
    v_cvt_pk_bf16_f32 v47, v34, v35
    v_lshlrev_b32 v28, 16, v44
    v_and_b32 v29, 0xffff0000, v44
    v_lshlrev_b32 v30, 16, v45
    v_and_b32 v31, 0xffff0000, v45
    v_lshlrev_b32 v32, 16, v46
    v_and_b32 v33, 0xffff0000, v46
    v_lshlrev_b32 v34, 16, v47
    v_and_b32 v35, 0xffff0000, v47
    v_add_f32 v28, s6, v28
    v_add_f32 v29, s6, v29
    v_add_f32 v30, s6, v30
    v_add_f32 v31, s6, v31
    v_add_f32 v32, s6, v32
    v_add_f32 v33, s6, v33
    v_add_f32 v34, s6, v34
    v_add_f32 v35, s6, v35
    v_cvt_pk_bf16_f32 v44, v28, v29
    v_cvt_pk_bf16_f32 v45, v30, v31
    v_cvt_pk_bf16_f32 v46, v32, v33
    v_cvt_pk_bf16_f32 v47, v34, v35
    v_lshlrev_b32 v28, 16, v44
    v_and_b32 v29, 0xffff0000, v44
    v_lshlrev_b32 v30, 16, v45
    v_and_b32 v31, 0xffff0000, v45
    v_lshlrev_b32 v32, 16, v46
    v_and_b32 v33, 0xffff0000, v46
    v_lshlrev_b32 v34, 16, v47
    v_and_b32 v35, 0xffff0000, v47
    ds_write_b128 v52, v[28:31]
    ds_write_b128 v53, v[32:35]
    s_add_u32 m0, s16, 86784
    s_nop 0
    buffer_load_dwordx4 v8, s[8:11], s17 offen offset:0 lds
    buffer_load_dwordx4 v9, s[8:11], s17 offen offset:1024 lds
    buffer_load_dwordx4 v10, s[8:11], s17 offen offset:2048 lds
    buffer_load_dwordx4 v11, s[8:11], s17 offen offset:3072 lds
    s_add_u32 m0, s16, 90880
    s_nop 0
    buffer_load_dwordx4 v12, s[8:11], s17 offen offset:0 lds
    buffer_load_dwordx4 v13, s[8:11], s17 offen offset:1024 lds
    buffer_load_dwordx4 v14, s[8:11], s17 offen offset:2048 lds
    s_add_u32 s17, s17, 229376
    s_waitcnt vmcnt(7)
    ds_write_b32 v120, v88 offset:0
    ds_write_b32 v120, v89 offset:1040
    ds_write_b32 v120, v90 offset:2080
    ds_write_b32 v120, v91 offset:3120
    ds_write_b32 v120, v92 offset:512
    ds_write_b32 v120, v93 offset:1552
    ds_write_b32 v120, v94 offset:2592
    ds_write_b32 v120, v95 offset:3632
    buffer_load_dwordx4 a[128:131], v3, s[36:39], s15 offen offset:0 sc1
    s_waitcnt lgkmcnt(0)
    s_barrier
    ds_read_b32 v28, v121 offset:0
    ds_read_b32 v29, v121 offset:128
    ds_read_b32 v30, v121 offset:64
    ds_read_b32 v31, v121 offset:192
    ds_read_b32 v32, v121 offset:4160
    ds_read_b32 v33, v121 offset:4288
    buffer_load_dwordx4 a[132:135], v3, s[36:39], s15 offen offset:1024 sc1
    ds_read_b32 v34, v121 offset:4224
    ds_read_b32 v35, v121 offset:4352
    ds_read_b32 v86, v128 offset:0
    ds_read_b32 v87, v128 offset:4160
    ds_read_b128 v[44:47], v127 offset:0
    ds_read_b128 v[48:51], v127 offset:1024
    s_waitcnt lgkmcnt(10)
    v_mfma_f32_16x16x16_bf16 v[148:151], v[28:29], v[64:65], 0
    buffer_load_dwordx4 a[136:139], v3, s[36:39], s15 offen offset:2048 sc1
    v_mfma_f32_16x16x16_bf16 v[164:167], v[28:29], v[66:67], 0
    s_waitcnt lgkmcnt(8)
    v_mfma_f32_16x16x16_bf16 v[152:155], v[30:31], v[64:65], 0
    v_mfma_f32_16x16x16_bf16 v[168:171], v[30:31], v[66:67], 0
    s_waitcnt lgkmcnt(6)
    v_mfma_f32_16x16x16_bf16 v[156:159], v[32:33], v[64:65], 0
    v_mfma_f32_16x16x16_bf16 v[172:175], v[32:33], v[66:67], 0
    s_waitcnt lgkmcnt(4)
    buffer_load_dwordx4 a[140:143], v3, s[36:39], s15 offen offset:3072 sc1
    s_add_u32 s15, s15, 4096
    v_mfma_f32_16x16x16_bf16 v[160:163], v[34:35], v[64:65], 0
    v_mfma_f32_16x16x16_bf16 v[176:179], v[34:35], v[66:67], 0
    ds_read_b128 v[132:135], v127 offset:2048
    ds_read_b128 v[136:139], v127 offset:3072
    ds_read_b128 v[140:143], v127 offset:4096
    ds_read_b128 v[144:147], v127 offset:5120
    s_waitcnt lgkmcnt(4)
    v_and_b32 v86, 0xffff0000, v86
    buffer_load_dwordx4 a[144:147], v3, s[36:39], s15 offen offset:0 sc1
    v_and_b32 v87, 0xffff0000, v87
    v_fmac_f32 v148, v85, v86
    v_fmac_f32 v156, v85, v87
    v_mul_f32 v180, v148, v68
    v_mul_f32 v188, v164, v68
    v_mul_f32 v181, v149, v69
    v_mul_f32 v189, v165, v69
    v_mul_f32 v182, v150, v70
    buffer_load_dwordx4 a[148:151], v3, s[36:39], s15 offen offset:1024 sc1
    v_mul_f32 v190, v166, v70
    v_mul_f32 v183, v151, v71
    v_mul_f32 v191, v167, v71
    v_fma_f32 v180, -v164, v76, v180
    v_fmac_f32 v188, v148, v76
    v_fma_f32 v181, -v165, v77, v181
    v_fmac_f32 v189, v149, v77
    v_fma_f32 v182, -v166, v78, v182
    buffer_load_dwordx4 a[152:155], v3, s[36:39], s15 offen offset:2048 sc1
    v_fmac_f32 v190, v150, v78
    v_fma_f32 v183, -v167, v79, v183
    v_fmac_f32 v191, v151, v79
    v_cvt_pk_bf16_f32 v196, v180, v181
    v_cvt_pk_bf16_f32 v197, v182, v183
    v_cvt_pk_bf16_f32 v198, v188, v189
    v_cvt_pk_bf16_f32 v199, v190, v191
    s_nop 1
    v_mfma_f32_16x16x32_bf16 v[212:215], v[196:199], v[96:99], 0
    buffer_load_dwordx4 a[156:159], v3, s[36:39], s15 offen offset:3072 sc1
    s_add_u32 s15, s15, 4096
    v_mfma_f32_16x16x32_bf16 v[216:219], v[196:199], v[104:107], 0
    v_mul_f32 v184, v156, v68
    v_mul_f32 v192, v172, v68
    v_mul_f32 v185, v157, v69
    v_mul_f32 v193, v173, v69
    v_mul_f32 v186, v158, v70
    v_mul_f32 v194, v174, v70
    v_mul_f32 v187, v159, v71
    buffer_load_dwordx4 a[160:163], v3, s[36:39], s15 offen offset:0 sc1
    v_mul_f32 v195, v175, v71
    v_fma_f32 v184, -v172, v76, v184
    v_fmac_f32 v192, v156, v76
    v_fma_f32 v185, -v173, v77, v185
    v_fmac_f32 v193, v157, v77
    v_fma_f32 v186, -v174, v78, v186
    v_fmac_f32 v194, v158, v78
    v_fma_f32 v187, -v175, v79, v187
    buffer_load_dwordx4 a[164:167], v3, s[36:39], s15 offen offset:1024 sc1
    v_fmac_f32 v195, v159, v79
    v_cvt_pk_bf16_f32 v204, v184, v185
    v_cvt_pk_bf16_f32 v205, v186, v187
    v_cvt_pk_bf16_f32 v206, v192, v193
    v_cvt_pk_bf16_f32 v207, v194, v195
    s_nop 1
    v_mfma_f32_16x16x32_bf16 v[220:223], v[204:207], v[96:99], 0
    v_mfma_f32_16x16x32_bf16 v[224:227], v[204:207], v[104:107], 0
    v_mul_f32 v180, v152, v72
    buffer_load_dwordx4 a[168:171], v3, s[36:39], s15 offen offset:2048 sc1
    v_mul_f32 v188, v168, v72
    v_mul_f32 v181, v153, v73
    v_mul_f32 v189, v169, v73
    v_mul_f32 v182, v154, v74
    v_mul_f32 v190, v170, v74
    v_mul_f32 v183, v155, v75
    v_mul_f32 v191, v171, v75
    v_fma_f32 v180, -v168, v80, v180
    buffer_load_dwordx4 a[172:175], v3, s[36:39], s15 offen offset:3072 sc1
    s_add_u32 s15, s15, 4096
    v_fmac_f32 v188, v152, v80
    v_fma_f32 v181, -v169, v81, v181
    v_fmac_f32 v189, v153, v81
    v_fma_f32 v182, -v170, v82, v182
    v_fmac_f32 v190, v154, v82
    v_fma_f32 v183, -v171, v83, v183
    v_fmac_f32 v191, v155, v83
    v_cvt_pk_bf16_f32 v200, v180, v181
    buffer_load_dwordx4 a[176:179], v3, s[36:39], s15 offen offset:0 sc1
    v_cvt_pk_bf16_f32 v201, v182, v183
    v_cvt_pk_bf16_f32 v202, v188, v189
    v_cvt_pk_bf16_f32 v203, v190, v191
    s_nop 1
    v_mfma_f32_16x16x32_bf16 v[212:215], v[200:203], v[100:103], v[212:215]
    v_mfma_f32_16x16x32_bf16 v[216:219], v[200:203], v[108:111], v[216:219]
    v_mul_f32 v184, v160, v72
    v_mul_f32 v192, v176, v72
    v_mul_f32 v185, v161, v73
    buffer_load_dwordx4 a[180:183], v3, s[36:39], s15 offen offset:1024 sc1
    v_mul_f32 v193, v177, v73
    v_mul_f32 v186, v162, v74
    v_mul_f32 v194, v178, v74
    v_mul_f32 v187, v163, v75
    v_mul_f32 v195, v179, v75
    v_fma_f32 v184, -v176, v80, v184
    v_fmac_f32 v192, v160, v80
    v_fma_f32 v185, -v177, v81, v185
    buffer_load_dwordx4 a[184:187], v3, s[36:39], s15 offen offset:2048 sc1
    v_fmac_f32 v193, v161, v81
    v_fma_f32 v186, -v178, v82, v186
    v_fmac_f32 v194, v162, v82
    v_fma_f32 v187, -v179, v83, v187
    v_fmac_f32 v195, v163, v83
    v_cvt_pk_bf16_f32 v208, v184, v185
    v_cvt_pk_bf16_f32 v209, v186, v187
    v_cvt_pk_bf16_f32 v210, v192, v193
    buffer_load_dwordx4 a[188:191], v3, s[36:39], s15 offen offset:3072 sc1
    s_add_u32 s15, s15, 4096
    v_cvt_pk_bf16_f32 v211, v194, v195
    s_nop 1
    v_mfma_f32_16x16x32_bf16 v[220:223], v[208:211], v[100:103], v[220:223]
    v_mfma_f32_16x16x32_bf16 v[224:227], v[208:211], v[108:111], v[224:227]
    v_lshlrev_b32 v228, 16, v36
    v_and_b32 v229, 0xffff0000, v36
    v_lshlrev_b32 v230, 16, v37
    v_and_b32 v231, 0xffff0000, v37
    v_lshlrev_b32 v232, 16, v38
    buffer_load_dwordx4 a[192:195], v3, s[36:39], s15 offen offset:0 sc1
    v_and_b32 v233, 0xffff0000, v38
    v_lshlrev_b32 v234, 16, v39
    v_and_b32 v235, 0xffff0000, v39
    v_lshlrev_b32 v236, 16, v40
    v_and_b32 v237, 0xffff0000, v40
    v_lshlrev_b32 v238, 16, v41
    v_and_b32 v239, 0xffff0000, v41
    v_lshlrev_b32 v240, 16, v42
    buffer_load_dwordx4 a[196:199], v3, s[36:39], s15 offen offset:1024 sc1
    v_and_b32 v241, 0xffff0000, v42
    v_lshlrev_b32 v242, 16, v43
    v_and_b32 v243, 0xffff0000, v43
    s_waitcnt lgkmcnt(0)
    v_fmac_f32 v228, v44, v212
    v_fmac_f32 v229, v45, v213
    v_fmac_f32 v230, v46, v214
    v_fmac_f32 v231, v47, v215
    buffer_load_dwordx4 a[200:203], v3, s[36:39], s15 offen offset:2048 sc1
    v_fmac_f32 v232, v48, v216
    v_fmac_f32 v233, v49, v217
    v_fmac_f32 v234, v50, v218
    v_fmac_f32 v235, v51, v219
    v_cvt_pk_bf16_f32 v36, v228, v229
    v_cvt_pk_bf16_f32 v37, v230, v231
    v_cvt_pk_bf16_f32 v38, v232, v233
    v_cvt_pk_bf16_f32 v39, v234, v235
    buffer_load_dwordx4 a[204:207], v3, s[36:39], s15 offen offset:3072 sc1
    s_add_u32 s15, s15, 4096
    ds_write_b64 v125, v[36:37] offset:0
    ds_write_b64 v125, v[38:39] offset:512
    v_fmac_f32 v236, v44, v220
    v_fmac_f32 v237, v45, v221
    v_fmac_f32 v238, v46, v222
    v_fmac_f32 v239, v47, v223
    v_fmac_f32 v240, v48, v224
    v_fmac_f32 v241, v49, v225
    buffer_load_dwordx4 a[208:211], v3, s[36:39], s15 offen offset:0 sc1
    v_fmac_f32 v242, v50, v226
    v_fmac_f32 v243, v51, v227
    v_cvt_pk_bf16_f32 v40, v236, v237
    v_cvt_pk_bf16_f32 v41, v238, v239
    v_cvt_pk_bf16_f32 v42, v240, v241
    v_cvt_pk_bf16_f32 v43, v242, v243
    ds_write_b64 v125, v[40:41] offset:1024
    ds_write_b64 v125, v[42:43] offset:1536
    buffer_load_dwordx4 a[212:215], v3, s[36:39], s15 offen offset:1024 sc1
    v_lshlrev_b32 v228, 16, v36
    v_and_b32 v229, 0xffff0000, v36
    v_lshlrev_b32 v230, 16, v37
    v_and_b32 v231, 0xffff0000, v37
    v_lshlrev_b32 v232, 16, v38
    v_and_b32 v233, 0xffff0000, v38
    v_lshlrev_b32 v234, 16, v39
    v_and_b32 v235, 0xffff0000, v39
    buffer_load_dwordx4 a[216:219], v3, s[36:39], s15 offen offset:2048 sc1
    v_lshlrev_b32 v236, 16, v40
    v_and_b32 v237, 0xffff0000, v40
    v_lshlrev_b32 v238, 16, v41
    v_and_b32 v239, 0xffff0000, v41
    v_lshlrev_b32 v240, 16, v42
    v_and_b32 v241, 0xffff0000, v42
    v_lshlrev_b32 v242, 16, v43
    v_and_b32 v243, 0xffff0000, v43
    buffer_load_dwordx4 a[220:223], v3, s[36:39], s15 offen offset:3072 sc1
    s_add_u32 s15, s15, 4096
    s_waitcnt lgkmcnt(0)
    ds_read_b128 v[88:91], v126 offset:0
    ds_read_b128 v[92:95], v126 offset:1024
    v_add_f32 v52, v228, v229
    v_add_f32 v129, v230, v231
    v_add_f32 v58, v232, v233
    v_add_f32 v59, v234, v235
    v_add_f32 v53, v236, v237
    v_add_f32 v130, v238, v239
    v_add_f32 v60, v240, v241
    v_add_f32 v61, v242, v243
    v_add_f32 v52, v52, v129
    v_add_f32 v58, v58, v59
    v_add_f32 v53, v53, v130
    v_add_f32 v60, v60, v61
    v_add_f32 v52, v52, v58
    v_add_f32 v53, v53, v60
    s_nop 0
    v_add_f32_dpp v52, v52, v52 row_ror:8 row_mask:0xf bank_mask:0xf
    v_add_f32_dpp v53, v53, v53 row_ror:8 row_mask:0xf bank_mask:0xf
    s_nop 0
    v_add_f32_dpp v52, v52, v52 row_ror:4 row_mask:0xf bank_mask:0xf
    v_add_f32_dpp v53, v53, v53 row_ror:4 row_mask:0xf bank_mask:0xf
    s_nop 0
    v_add_f32_dpp v52, v52, v52 row_ror:2 row_mask:0xf bank_mask:0xf
    v_add_f32_dpp v53, v53, v53 row_ror:2 row_mask:0xf bank_mask:0xf
    s_nop 0
    v_add_f32_dpp v52, v52, v52 row_ror:1 row_mask:0xf bank_mask:0xf
    v_add_f32_dpp v53, v53, v53 row_ror:1 row_mask:0xf bank_mask:0xf
    v_mov_b32 v129, v52
    v_mov_b32 v130, v53
    s_nop 0
    v_permlane16_swap_b32 v52, v129
    v_permlane16_swap_b32 v53, v130
    v_add_f32 v52, v52, v129
    v_add_f32 v53, v53, v130
    v_mov_b32 v129, v52
    v_mov_b32 v130, v53
    s_nop 0
    v_permlane32_swap_b32 v52, v129
    v_permlane32_swap_b32 v53, v130
    v_add_f32 v52, v52, v129
    v_add_f32 v53, v53, v130
    s_waitcnt lgkmcnt(0)
    buffer_store_dwordx4 v[88:91], v3, s[36:39], s12 offen sc1
    s_add_u32 s12, s12, 4096
    buffer_store_dwordx4 v[92:95], v3, s[36:39], s12 offen sc1
    v_mul_f32 v52, 0xbb000000, v52
    v_mul_f32 v53, 0xbb000000, v53
    v_add_f32 v228, v228, v52
    v_add_f32 v229, v229, v52
    v_add_f32 v230, v230, v52
    v_add_f32 v231, v231, v52
    v_add_f32 v232, v232, v52
    v_add_f32 v233, v233, v52
    v_add_f32 v234, v234, v52
    v_add_f32 v235, v235, v52
    v_add_f32 v236, v236, v53
    v_add_f32 v237, v237, v53
    v_add_f32 v238, v238, v53
    v_add_f32 v239, v239, v53
    v_add_f32 v240, v240, v53
    v_add_f32 v241, v241, v53
    v_add_f32 v242, v242, v53
    v_add_f32 v243, v243, v53
    v_mul_f32 v52, v228, v228
    v_mul_f32 v58, v229, v229
    v_mul_f32 v53, v236, v236
    v_mul_f32 v60, v237, v237
    v_fmac_f32 v52, v230, v230
    v_fmac_f32 v58, v231, v231
    v_fmac_f32 v53, v238, v238
    v_fmac_f32 v60, v239, v239
    v_fmac_f32 v52, v232, v232
    v_fmac_f32 v58, v233, v233
    v_fmac_f32 v53, v240, v240
    v_fmac_f32 v60, v241, v241
    v_fmac_f32 v52, v234, v234
    v_fmac_f32 v58, v235, v235
    v_fmac_f32 v53, v242, v242
    v_fmac_f32 v60, v243, v243
    v_add_f32 v52, v52, v58
    v_add_f32 v53, v53, v60
    s_nop 0
    v_add_f32_dpp v52, v52, v52 row_ror:8 row_mask:0xf bank_mask:0xf
    v_add_f32_dpp v53, v53, v53 row_ror:8 row_mask:0xf bank_mask:0xf
    s_nop 0
    v_add_f32_dpp v52, v52, v52 row_ror:4 row_mask:0xf bank_mask:0xf
    v_add_f32_dpp v53, v53, v53 row_ror:4 row_mask:0xf bank_mask:0xf
    s_nop 0
    v_add_f32_dpp v52, v52, v52 row_ror:2 row_mask:0xf bank_mask:0xf
    v_add_f32_dpp v53, v53, v53 row_ror:2 row_mask:0xf bank_mask:0xf
    s_nop 0
    v_add_f32_dpp v52, v52, v52 row_ror:1 row_mask:0xf bank_mask:0xf
    v_add_f32_dpp v53, v53, v53 row_ror:1 row_mask:0xf bank_mask:0xf
    v_mov_b32 v129, v52
    v_mov_b32 v130, v53
    s_nop 0
    v_permlane16_swap_b32 v52, v129
    v_permlane16_swap_b32 v53, v130
    v_add_f32 v52, v52, v129
    v_add_f32 v53, v53, v130
    v_mov_b32 v129, v52
    v_mov_b32 v130, v53
    s_nop 0
    v_permlane32_swap_b32 v52, v129
    v_permlane32_swap_b32 v53, v130
    v_add_f32 v52, v52, v129
    v_add_f32 v53, v53, v130
    v_mov_b32 v129, 0x3727c5ac
    v_fmac_f32 v129, 0x3b000000, v52
    v_mov_b32 v130, 0x3727c5ac
    v_fmac_f32 v130, 0x3b000000, v53
    v_rsq_f32 v129, v129
    v_rsq_f32 v130, v130
    v_mul_f32 v228, v228, v129
    v_mul_f32 v229, v229, v129
    v_mul_f32 v230, v230, v129
    v_mul_f32 v231, v231, v129
    v_mul_f32 v232, v232, v129
    v_mul_f32 v233, v233, v129
    v_mul_f32 v234, v234, v129
    v_mul_f32 v235, v235, v129
    v_mul_f32 v236, v236, v130
    v_mul_f32 v237, v237, v130
    v_mul_f32 v238, v238, v130
    v_mul_f32 v239, v239, v130
    v_mul_f32 v240, v240, v130
    v_mul_f32 v241, v241, v130
    v_mul_f32 v242, v242, v130
    v_mul_f32 v243, v243, v130
    v_fma_f32 v228, v228, v140, v132
    v_fma_f32 v229, v229, v141, v133
    v_fma_f32 v230, v230, v142, v134
    v_fma_f32 v231, v231, v143, v135
    v_fma_f32 v232, v232, v144, v136
    v_fma_f32 v233, v233, v145, v137
    v_fma_f32 v234, v234, v146, v138
    v_fma_f32 v235, v235, v147, v139
    v_cvt_pk_bf16_f32 v36, v228, v229
    v_cvt_pk_bf16_f32 v37, v230, v231
    ds_write_b64 v122, v[36:37] offset:0
    v_cvt_pk_bf16_f32 v38, v232, v233
    v_cvt_pk_bf16_f32 v39, v234, v235
    ds_write_b64 v122, v[38:39] offset:4224
    v_fma_f32 v236, v236, v140, v132
    v_fma_f32 v237, v237, v141, v133
    v_fma_f32 v238, v238, v142, v134
    v_fma_f32 v239, v239, v143, v135
    v_fma_f32 v240, v240, v144, v136
    v_fma_f32 v241, v241, v145, v137
    v_fma_f32 v242, v242, v146, v138
    v_fma_f32 v243, v243, v147, v139
    v_cvt_pk_bf16_f32 v40, v236, v237
    v_cvt_pk_bf16_f32 v41, v238, v239
    ds_write_b64 v122, v[40:41] offset:64
    v_cvt_pk_bf16_f32 v42, v240, v241
    v_cvt_pk_bf16_f32 v43, v242, v243
    ds_write_b64 v122, v[42:43] offset:4288
    s_waitcnt lgkmcnt(0)
    s_barrier
    ds_read_b128 v[228:231], v123 offset:0
    ds_read_b128 v[236:239], v123 offset:4224
    s_waitcnt lgkmcnt(1)
    buffer_store_dwordx4 v[228:231], v124, s[36:39], s7 offen sc1
    s_add_u32 s7, s7, 8192
    s_waitcnt lgkmcnt(0)
    buffer_store_dwordx4 v[236:239], v124, s[36:39], s7 offen sc1
    s_lshl_b32 s4, s32, 7
    s_add_u32 s4, s4, 0x1300000
    v_mov_b32 v6, s34
    s_waitcnt vmcnt(0)
    s_barrier
    s_cmp_lg_u32 s3, 0
    s_cbranch_scc1 adaLN_cond__spectral_gfnet__glu_gated_bilinear__prompt_kernel_PUB46
    s_mov_b64 exec, 1
    buffer_store_dword v6, v4, s[36:39], s4 offen sc1
    s_mov_b64 exec, -1
adaLN_cond__spectral_gfnet__glu_gated_bilinear__prompt_kernel_PUB46:
    s_add_u32 m0, s16, 115712
    s_nop 0
    buffer_load_dwordx4 v8, s[8:11], s17 offen offset:0 lds
    buffer_load_dwordx4 v9, s[8:11], s17 offen offset:1024 lds
    buffer_load_dwordx4 v10, s[8:11], s17 offen offset:2048 lds
    buffer_load_dwordx4 v11, s[8:11], s17 offen offset:3072 lds
    s_add_u32 m0, s16, 119808
    s_nop 0
    buffer_load_dwordx4 v12, s[8:11], s17 offen offset:0 lds
    buffer_load_dwordx4 v13, s[8:11], s17 offen offset:1024 lds
    buffer_load_dwordx4 v14, s[8:11], s17 offen offset:2048 lds
    s_add_u32 s17, s17, 229376
    v_lshlrev_b32 v5, 7, v1
    s_lshl_b32 s5, s30, 4
    s_lshl_b32 s28, s3, 2
    s_add_u32 s5, s5, s28
    s_lshl_b32 s5, s5, 7
    s_add_u32 s5, s5, 0x1300000
    s_lshl_b32 s7, s30, 2
    s_add_u32 s7, s7, s3
    s_lshl_b32 s6, s7, 15
    s_add_u32 s6, s6, 0x840000
    s_add_u32 s12, s6, 16384
    v_lshrrev_b32 v21, 2, v1
    v_mul_u32_u24 v15, 224, v21
    v_and_b32 v20, 3, v1
    v_lshl_add_u32 v15, v20, 3, v15
    v_add_u32 v16, 28928, v15
    v_add_u32 v17, 57856, v15
    v_add_u32 v18, 86784, v15
    v_add_u32 v19, 115712, v15
    s_mul_i32 s19, s7, 112
    s_mul_i32 s28, s31, 7
    s_add_u32 s19, s19, s28
    s_lshl_b32 s19, s19, 10
    s_add_u32 s19, s19, 0xa40000
    ds_read_b64_tr_b16 v[136:137], v15 offset:0
    ds_read_b64_tr_b16 v[138:139], v15 offset:3584
    ds_read_b64_tr_b16 v[140:141], v15 offset:32
    ds_read_b64_tr_b16 v[142:143], v15 offset:3616
    ds_read_b64_tr_b16 v[144:145], v15 offset:64
    ds_read_b64_tr_b16 v[146:147], v15 offset:3648
    ds_read_b64_tr_b16 v[148:149], v15 offset:96
    ds_read_b64_tr_b16 v[150:151], v15 offset:3680
    ds_read_b64_tr_b16 v[152:153], v15 offset:128
    ds_read_b64_tr_b16 v[154:155], v15 offset:3712
    ds_read_b64_tr_b16 v[156:157], v15 offset:160
    ds_read_b64_tr_b16 v[158:159], v15 offset:3744
    ds_read_b64_tr_b16 v[160:161], v15 offset:192
    ds_read_b64_tr_b16 v[162:163], v15 offset:3776
    ds_read_b64_tr_b16 v[164:165], v15 offset:14464
    ds_read_b64_tr_b16 v[166:167], v15 offset:18048
    ds_read_b64_tr_b16 v[168:169], v15 offset:14496
    ds_read_b64_tr_b16 v[170:171], v15 offset:18080
    ds_read_b64_tr_b16 v[172:173], v15 offset:14528
    ds_read_b64_tr_b16 v[174:175], v15 offset:18112
    ds_read_b64_tr_b16 v[176:177], v15 offset:14560
    ds_read_b64_tr_b16 v[178:179], v15 offset:18144
    ds_read_b64_tr_b16 v[180:181], v15 offset:14592
    ds_read_b64_tr_b16 v[182:183], v15 offset:18176
    ds_read_b64_tr_b16 v[184:185], v15 offset:14624
    ds_read_b64_tr_b16 v[186:187], v15 offset:18208
    ds_read_b64_tr_b16 v[188:189], v15 offset:14656
    ds_read_b64_tr_b16 v[190:191], v15 offset:18240
    s_mov_b32 s18, 0
    s_mov_b64 exec, 15
adaLN_cond__spectral_gfnet__glu_gated_bilinear__prompt_kernel_POLLA47:
    buffer_load_dword v7, v5, s[36:39], s5 offen sc1
    s_add_u32 s18, s18, 1
    s_waitcnt vmcnt(0)
    v_cmp_ne_u32 vcc, s34, v7
    s_nop 0
    s_cbranch_vccz adaLN_cond__spectral_gfnet__glu_gated_bilinear__prompt_kernel_POLLAD48
    s_cmp_lt_u32 s18, 0x20000
    s_cbranch_scc1 adaLN_cond__spectral_gfnet__glu_gated_bilinear__prompt_kernel_POLLA47
adaLN_cond__spectral_gfnet__glu_gated_bilinear__prompt_kernel_POLLAD48:
    s_mov_b64 exec, -1
    buffer_load_dwordx4 a[0:3], v3, s[36:39], s6 offen offset:0 sc1
    buffer_load_dwordx4 a[4:7], v3, s[36:39], s12 offen offset:0 sc1
    buffer_load_dwordx4 a[8:11], v3, s[36:39], s6 offen offset:1024 sc1
    buffer_load_dwordx4 a[12:15], v3, s[36:39], s12 offen offset:1024 sc1
    buffer_load_dwordx4 a[16:19], v3, s[36:39], s6 offen offset:2048 sc1
    buffer_load_dwordx4 a[20:23], v3, s[36:39], s12 offen offset:2048 sc1
    buffer_load_dwordx4 a[24:27], v3, s[36:39], s6 offen offset:3072 sc1
    s_add_u32 s6, s6, 4096
    buffer_load_dwordx4 a[28:31], v3, s[36:39], s12 offen offset:3072 sc1
    s_add_u32 s12, s12, 4096
    buffer_load_dwordx4 a[32:35], v3, s[36:39], s6 offen offset:0 sc1
    buffer_load_dwordx4 a[36:39], v3, s[36:39], s12 offen offset:0 sc1
    buffer_load_dwordx4 a[40:43], v3, s[36:39], s6 offen offset:1024 sc1
    buffer_load_dwordx4 a[44:47], v3, s[36:39], s12 offen offset:1024 sc1
    buffer_load_dwordx4 a[48:51], v3, s[36:39], s6 offen offset:2048 sc1
    buffer_load_dwordx4 a[52:55], v3, s[36:39], s12 offen offset:2048 sc1
    buffer_load_dwordx4 a[56:59], v3, s[36:39], s6 offen offset:3072 sc1
    s_add_u32 s6, s6, 4096
    buffer_load_dwordx4 a[60:63], v3, s[36:39], s12 offen offset:3072 sc1
    s_add_u32 s12, s12, 4096
    buffer_load_dwordx4 a[64:67], v3, s[36:39], s6 offen offset:0 sc1
    buffer_load_dwordx4 a[68:71], v3, s[36:39], s12 offen offset:0 sc1
    buffer_load_dwordx4 a[72:75], v3, s[36:39], s6 offen offset:1024 sc1
    buffer_load_dwordx4 a[76:79], v3, s[36:39], s12 offen offset:1024 sc1
    buffer_load_dwordx4 a[80:83], v3, s[36:39], s6 offen offset:2048 sc1
    buffer_load_dwordx4 a[84:87], v3, s[36:39], s12 offen offset:2048 sc1
    buffer_load_dwordx4 a[88:91], v3, s[36:39], s6 offen offset:3072 sc1
    s_add_u32 s6, s6, 4096
    buffer_load_dwordx4 a[92:95], v3, s[36:39], s12 offen offset:3072 sc1
    s_add_u32 s12, s12, 4096
    s_waitcnt vmcnt(22) lgkmcnt(14)
    v_mfma_f32_16x16x32_bf16 v[24:27], v[136:139], a[0:3], 0
    buffer_load_dwordx4 a[96:99], v3, s[36:39], s6 offen offset:0 sc1
    v_mfma_f32_16x16x32_bf16 v[28:31], v[136:139], a[4:7], 0
    ds_read_b64_tr_b16 v[136:137], v15 offset:7168
    v_mfma_f32_16x16x32_bf16 v[40:43], v[140:143], a[0:3], 0
    ds_read_b64_tr_b16 v[138:139], v15 offset:10752
    v_mfma_f32_16x16x32_bf16 v[44:47], v[140:143], a[4:7], 0
    ds_read_b64_tr_b16 v[140:141], v15 offset:7200
    v_mfma_f32_16x16x32_bf16 v[56:59], v[144:147], a[0:3], 0
    ds_read_b64_tr_b16 v[142:143], v15 offset:10784
    v_mfma_f32_16x16x32_bf16 v[60:63], v[144:147], a[4:7], 0
    ds_read_b64_tr_b16 v[144:145], v15 offset:7232
    v_mfma_f32_16x16x32_bf16 v[72:75], v[148:151], a[0:3], 0
    ds_read_b64_tr_b16 v[146:147], v15 offset:10816
    v_mfma_f32_16x16x32_bf16 v[76:79], v[148:151], a[4:7], 0
    ds_read_b64_tr_b16 v[148:149], v15 offset:7264
    v_mfma_f32_16x16x32_bf16 v[88:91], v[152:155], a[0:3], 0
    ds_read_b64_tr_b16 v[150:151], v15 offset:10848
    v_mfma_f32_16x16x32_bf16 v[92:95], v[152:155], a[4:7], 0
    ds_read_b64_tr_b16 v[152:153], v15 offset:7296
    v_mfma_f32_16x16x32_bf16 v[104:107], v[156:159], a[0:3], 0
    ds_read_b64_tr_b16 v[154:155], v15 offset:10880
    v_mfma_f32_16x16x32_bf16 v[108:111], v[156:159], a[4:7], 0
    ds_read_b64_tr_b16 v[156:157], v15 offset:7328
    v_mfma_f32_16x16x32_bf16 v[120:123], v[160:163], a[0:3], 0
    ds_read_b64_tr_b16 v[158:159], v15 offset:10912
    v_mfma_f32_16x16x32_bf16 v[124:127], v[160:163], a[4:7], 0
    ds_read_b64_tr_b16 v[160:161], v15 offset:7360
    ds_read_b64_tr_b16 v[162:163], v15 offset:10944
    s_waitcnt lgkmcnt(14)
    v_mfma_f32_16x16x32_bf16 v[32:35], v[164:167], a[0:3], 0
    buffer_load_dwordx4 a[100:103], v3, s[36:39], s12 offen offset:0 sc1
    v_mfma_f32_16x16x32_bf16 v[36:39], v[164:167], a[4:7], 0
    ds_read_b64_tr_b16 v[164:165], v15 offset:21632
    v_mfma_f32_16x16x32_bf16 v[48:51], v[168:171], a[0:3], 0
    ds_read_b64_tr_b16 v[166:167], v15 offset:25216
    v_mfma_f32_16x16x32_bf16 v[52:55], v[168:171], a[4:7], 0
    ds_read_b64_tr_b16 v[168:169], v15 offset:21664
    v_mfma_f32_16x16x32_bf16 v[64:67], v[172:175], a[0:3], 0
    ds_read_b64_tr_b16 v[170:171], v15 offset:25248
    v_mfma_f32_16x16x32_bf16 v[68:71], v[172:175], a[4:7], 0
    ds_read_b64_tr_b16 v[172:173], v15 offset:21696
    v_mfma_f32_16x16x32_bf16 v[80:83], v[176:179], a[0:3], 0
    ds_read_b64_tr_b16 v[174:175], v15 offset:25280
    v_mfma_f32_16x16x32_bf16 v[84:87], v[176:179], a[4:7], 0
    ds_read_b64_tr_b16 v[176:177], v15 offset:21728
    v_mfma_f32_16x16x32_bf16 v[96:99], v[180:183], a[0:3], 0
    ds_read_b64_tr_b16 v[178:179], v15 offset:25312
    v_mfma_f32_16x16x32_bf16 v[100:103], v[180:183], a[4:7], 0
    ds_read_b64_tr_b16 v[180:181], v15 offset:21760
    v_mfma_f32_16x16x32_bf16 v[112:115], v[184:187], a[0:3], 0
    ds_read_b64_tr_b16 v[182:183], v15 offset:25344
    v_mfma_f32_16x16x32_bf16 v[116:119], v[184:187], a[4:7], 0
    ds_read_b64_tr_b16 v[184:185], v15 offset:21792
    v_mfma_f32_16x16x32_bf16 v[128:131], v[188:191], a[0:3], 0
    ds_read_b64_tr_b16 v[186:187], v15 offset:25376
    v_mfma_f32_16x16x32_bf16 v[132:135], v[188:191], a[4:7], 0
    ds_read_b64_tr_b16 v[188:189], v15 offset:21824
    ds_read_b64_tr_b16 v[190:191], v15 offset:25408
    s_waitcnt vmcnt(22) lgkmcnt(14)
    s_barrier
    v_mfma_f32_16x16x32_bf16 v[24:27], v[136:139], a[8:11], v[24:27]
    buffer_load_dwordx4 a[104:107], v3, s[36:39], s6 offen offset:1024 sc1
    v_mfma_f32_16x16x32_bf16 v[28:31], v[136:139], a[12:15], v[28:31]
    ds_read_b64_tr_b16 v[136:137], v16 offset:0
    v_mfma_f32_16x16x32_bf16 v[40:43], v[140:143], a[8:11], v[40:43]
    ds_read_b64_tr_b16 v[138:139], v16 offset:3584
    v_mfma_f32_16x16x32_bf16 v[44:47], v[140:143], a[12:15], v[44:47]
    ds_read_b64_tr_b16 v[140:141], v16 offset:32
    v_mfma_f32_16x16x32_bf16 v[56:59], v[144:147], a[8:11], v[56:59]
    ds_read_b64_tr_b16 v[142:143], v16 offset:3616
    v_mfma_f32_16x16x32_bf16 v[60:63], v[144:147], a[12:15], v[60:63]
    ds_read_b64_tr_b16 v[144:145], v16 offset:64
    v_mfma_f32_16x16x32_bf16 v[72:75], v[148:151], a[8:11], v[72:75]
    ds_read_b64_tr_b16 v[146:147], v16 offset:3648
    v_mfma_f32_16x16x32_bf16 v[76:79], v[148:151], a[12:15], v[76:79]
    ds_read_b64_tr_b16 v[148:149], v16 offset:96
    v_mfma_f32_16x16x32_bf16 v[88:91], v[152:155], a[8:11], v[88:91]
    ds_read_b64_tr_b16 v[150:151], v16 offset:3680
    v_mfma_f32_16x16x32_bf16 v[92:95], v[152:155], a[12:15], v[92:95]
    ds_read_b64_tr_b16 v[152:153], v16 offset:128
    v_mfma_f32_16x16x32_bf16 v[104:107], v[156:159], a[8:11], v[104:107]
    ds_read_b64_tr_b16 v[154:155], v16 offset:3712
    v_mfma_f32_16x16x32_bf16 v[108:111], v[156:159], a[12:15], v[108:111]
    ds_read_b64_tr_b16 v[156:157], v16 offset:160
    v_mfma_f32_16x16x32_bf16 v[120:123], v[160:163], a[8:11], v[120:123]
    ds_read_b64_tr_b16 v[158:159], v16 offset:3744
    v_mfma_f32_16x16x32_bf16 v[124:127], v[160:163], a[12:15], v[124:127]
    ds_read_b64_tr_b16 v[160:161], v16 offset:192
    ds_read_b64_tr_b16 v[162:163], v16 offset:3776
    s_waitcnt lgkmcnt(14)
    v_mfma_f32_16x16x32_bf16 v[32:35], v[164:167], a[8:11], v[32:35]
    buffer_load_dwordx4 a[108:111], v3, s[36:39], s12 offen offset:1024 sc1
    v_mfma_f32_16x16x32_bf16 v[36:39], v[164:167], a[12:15], v[36:39]
    ds_read_b64_tr_b16 v[164:165], v16 offset:14464
    v_mfma_f32_16x16x32_bf16 v[48:51], v[168:171], a[8:11], v[48:51]
    ds_read_b64_tr_b16 v[166:167], v16 offset:18048
    v_mfma_f32_16x16x32_bf16 v[52:55], v[168:171], a[12:15], v[52:55]
    ds_read_b64_tr_b16 v[168:169], v16 offset:14496
    v_mfma_f32_16x16x32_bf16 v[64:67], v[172:175], a[8:11], v[64:67]
    ds_read_b64_tr_b16 v[170:171], v16 offset:18080
    v_mfma_f32_16x16x32_bf16 v[68:71], v[172:175], a[12:15], v[68:71]
    ds_read_b64_tr_b16 v[172:173], v16 offset:14528
    v_mfma_f32_16x16x32_bf16 v[80:83], v[176:179], a[8:11], v[80:83]
    ds_read_b64_tr_b16 v[174:175], v16 offset:18112
    v_mfma_f32_16x16x32_bf16 v[84:87], v[176:179], a[12:15], v[84:87]
    ds_read_b64_tr_b16 v[176:177], v16 offset:14560
    v_mfma_f32_16x16x32_bf16 v[96:99], v[180:183], a[8:11], v[96:99]
    ds_read_b64_tr_b16 v[178:179], v16 offset:18144
    v_mfma_f32_16x16x32_bf16 v[100:103], v[180:183], a[12:15], v[100:103]
    ds_read_b64_tr_b16 v[180:181], v16 offset:14592
    v_mfma_f32_16x16x32_bf16 v[112:115], v[184:187], a[8:11], v[112:115]
    ds_read_b64_tr_b16 v[182:183], v16 offset:18176
    v_mfma_f32_16x16x32_bf16 v[116:119], v[184:187], a[12:15], v[116:119]
    ds_read_b64_tr_b16 v[184:185], v16 offset:14624
    v_mfma_f32_16x16x32_bf16 v[128:131], v[188:191], a[8:11], v[128:131]
    ds_read_b64_tr_b16 v[186:187], v16 offset:18208
    v_mfma_f32_16x16x32_bf16 v[132:135], v[188:191], a[12:15], v[132:135]
    ds_read_b64_tr_b16 v[188:189], v16 offset:14656
    ds_read_b64_tr_b16 v[190:191], v16 offset:18240
    s_waitcnt vmcnt(22) lgkmcnt(14)
    v_mfma_f32_16x16x32_bf16 v[24:27], v[136:139], a[16:19], v[24:27]
    buffer_load_dwordx4 a[112:115], v3, s[36:39], s6 offen offset:2048 sc1
    v_mfma_f32_16x16x32_bf16 v[28:31], v[136:139], a[20:23], v[28:31]
    ds_read_b64_tr_b16 v[136:137], v16 offset:7168
    v_mfma_f32_16x16x32_bf16 v[40:43], v[140:143], a[16:19], v[40:43]
    ds_read_b64_tr_b16 v[138:139], v16 offset:10752
    v_mfma_f32_16x16x32_bf16 v[44:47], v[140:143], a[20:23], v[44:47]
    ds_read_b64_tr_b16 v[140:141], v16 offset:7200
    v_mfma_f32_16x16x32_bf16 v[56:59], v[144:147], a[16:19], v[56:59]
    ds_read_b64_tr_b16 v[142:143], v16 offset:10784
    v_mfma_f32_16x16x32_bf16 v[60:63], v[144:147], a[20:23], v[60:63]
    ds_read_b64_tr_b16 v[144:145], v16 offset:7232
    v_mfma_f32_16x16x32_bf16 v[72:75], v[148:151], a[16:19], v[72:75]
    ds_read_b64_tr_b16 v[146:147], v16 offset:10816
    v_mfma_f32_16x16x32_bf16 v[76:79], v[148:151], a[20:23], v[76:79]
    ds_read_b64_tr_b16 v[148:149], v16 offset:7264
    v_mfma_f32_16x16x32_bf16 v[88:91], v[152:155], a[16:19], v[88:91]
    ds_read_b64_tr_b16 v[150:151], v16 offset:10848
    v_mfma_f32_16x16x32_bf16 v[92:95], v[152:155], a[20:23], v[92:95]
    ds_read_b64_tr_b16 v[152:153], v16 offset:7296
    v_mfma_f32_16x16x32_bf16 v[104:107], v[156:159], a[16:19], v[104:107]
    ds_read_b64_tr_b16 v[154:155], v16 offset:10880
    v_mfma_f32_16x16x32_bf16 v[108:111], v[156:159], a[20:23], v[108:111]
    ds_read_b64_tr_b16 v[156:157], v16 offset:7328
    v_mfma_f32_16x16x32_bf16 v[120:123], v[160:163], a[16:19], v[120:123]
    ds_read_b64_tr_b16 v[158:159], v16 offset:10912
    v_mfma_f32_16x16x32_bf16 v[124:127], v[160:163], a[20:23], v[124:127]
    ds_read_b64_tr_b16 v[160:161], v16 offset:7360
    ds_read_b64_tr_b16 v[162:163], v16 offset:10944
    s_waitcnt lgkmcnt(14)
    v_mfma_f32_16x16x32_bf16 v[32:35], v[164:167], a[16:19], v[32:35]
    buffer_load_dwordx4 a[116:119], v3, s[36:39], s12 offen offset:2048 sc1
    v_mfma_f32_16x16x32_bf16 v[36:39], v[164:167], a[20:23], v[36:39]
    ds_read_b64_tr_b16 v[164:165], v16 offset:21632
    v_mfma_f32_16x16x32_bf16 v[48:51], v[168:171], a[16:19], v[48:51]
    ds_read_b64_tr_b16 v[166:167], v16 offset:25216
    v_mfma_f32_16x16x32_bf16 v[52:55], v[168:171], a[20:23], v[52:55]
    ds_read_b64_tr_b16 v[168:169], v16 offset:21664
    v_mfma_f32_16x16x32_bf16 v[64:67], v[172:175], a[16:19], v[64:67]
    ds_read_b64_tr_b16 v[170:171], v16 offset:25248
    v_mfma_f32_16x16x32_bf16 v[68:71], v[172:175], a[20:23], v[68:71]
    ds_read_b64_tr_b16 v[172:173], v16 offset:21696
    v_mfma_f32_16x16x32_bf16 v[80:83], v[176:179], a[16:19], v[80:83]
    ds_read_b64_tr_b16 v[174:175], v16 offset:25280
    v_mfma_f32_16x16x32_bf16 v[84:87], v[176:179], a[20:23], v[84:87]
    ds_read_b64_tr_b16 v[176:177], v16 offset:21728
    v_mfma_f32_16x16x32_bf16 v[96:99], v[180:183], a[16:19], v[96:99]
    ds_read_b64_tr_b16 v[178:179], v16 offset:25312
    v_mfma_f32_16x16x32_bf16 v[100:103], v[180:183], a[20:23], v[100:103]
    ds_read_b64_tr_b16 v[180:181], v16 offset:21760
    v_mfma_f32_16x16x32_bf16 v[112:115], v[184:187], a[16:19], v[112:115]
    ds_read_b64_tr_b16 v[182:183], v16 offset:25344
    v_mfma_f32_16x16x32_bf16 v[116:119], v[184:187], a[20:23], v[116:119]
    ds_read_b64_tr_b16 v[184:185], v16 offset:21792
    v_mfma_f32_16x16x32_bf16 v[128:131], v[188:191], a[16:19], v[128:131]
    ds_read_b64_tr_b16 v[186:187], v16 offset:25376
    v_mfma_f32_16x16x32_bf16 v[132:135], v[188:191], a[20:23], v[132:135]
    ds_read_b64_tr_b16 v[188:189], v16 offset:21824
    ds_read_b64_tr_b16 v[190:191], v16 offset:25408
    s_waitcnt vmcnt(22) lgkmcnt(14)
    s_barrier
    v_mfma_f32_16x16x32_bf16 v[24:27], v[136:139], a[24:27], v[24:27]
    buffer_load_dwordx4 a[120:123], v3, s[36:39], s6 offen offset:3072 sc1
    s_add_u32 s6, s6, 4096
    v_mfma_f32_16x16x32_bf16 v[28:31], v[136:139], a[28:31], v[28:31]
    ds_read_b64_tr_b16 v[136:137], v17 offset:0
    v_mfma_f32_16x16x32_bf16 v[40:43], v[140:143], a[24:27], v[40:43]
    ds_read_b64_tr_b16 v[138:139], v17 offset:3584
    s_add_u32 m0, s16, 0
    s_nop 0
    buffer_load_dwordx4 v8, s[8:11], s17 offen offset:0 lds
    v_mfma_f32_16x16x32_bf16 v[44:47], v[140:143], a[28:31], v[44:47]
    ds_read_b64_tr_b16 v[140:141], v17 offset:32
    v_mfma_f32_16x16x32_bf16 v[56:59], v[144:147], a[24:27], v[56:59]
    ds_read_b64_tr_b16 v[142:143], v17 offset:3616
    v_mfma_f32_16x16x32_bf16 v[60:63], v[144:147], a[28:31], v[60:63]
    ds_read_b64_tr_b16 v[144:145], v17 offset:64
    v_mfma_f32_16x16x32_bf16 v[72:75], v[148:151], a[24:27], v[72:75]
    ds_read_b64_tr_b16 v[146:147], v17 offset:3648
    buffer_load_dwordx4 v9, s[8:11], s17 offen offset:1024 lds
    v_mfma_f32_16x16x32_bf16 v[76:79], v[148:151], a[28:31], v[76:79]
    ds_read_b64_tr_b16 v[148:149], v17 offset:96
    v_mfma_f32_16x16x32_bf16 v[88:91], v[152:155], a[24:27], v[88:91]
    ds_read_b64_tr_b16 v[150:151], v17 offset:3680
    v_mfma_f32_16x16x32_bf16 v[92:95], v[152:155], a[28:31], v[92:95]
    ds_read_b64_tr_b16 v[152:153], v17 offset:128
    v_mfma_f32_16x16x32_bf16 v[104:107], v[156:159], a[24:27], v[104:107]
    ds_read_b64_tr_b16 v[154:155], v17 offset:3712
    buffer_load_dwordx4 v10, s[8:11], s17 offen offset:2048 lds
    v_mfma_f32_16x16x32_bf16 v[108:111], v[156:159], a[28:31], v[108:111]
    ds_read_b64_tr_b16 v[156:157], v17 offset:160
    v_mfma_f32_16x16x32_bf16 v[120:123], v[160:163], a[24:27], v[120:123]
    ds_read_b64_tr_b16 v[158:159], v17 offset:3744
    v_mfma_f32_16x16x32_bf16 v[124:127], v[160:163], a[28:31], v[124:127]
    ds_read_b64_tr_b16 v[160:161], v17 offset:192
    ds_read_b64_tr_b16 v[162:163], v17 offset:3776
    s_waitcnt lgkmcnt(14)
    v_mfma_f32_16x16x32_bf16 v[32:35], v[164:167], a[24:27], v[32:35]
    buffer_load_dwordx4 a[124:127], v3, s[36:39], s12 offen offset:3072 sc1
    s_add_u32 s12, s12, 4096
    v_mfma_f32_16x16x32_bf16 v[36:39], v[164:167], a[28:31], v[36:39]
    ds_read_b64_tr_b16 v[164:165], v17 offset:14464
    v_mfma_f32_16x16x32_bf16 v[48:51], v[168:171], a[24:27], v[48:51]
    ds_read_b64_tr_b16 v[166:167], v17 offset:18048
    buffer_load_dwordx4 v11, s[8:11], s17 offen offset:3072 lds
    v_mfma_f32_16x16x32_bf16 v[52:55], v[168:171], a[28:31], v[52:55]
    ds_read_b64_tr_b16 v[168:169], v17 offset:14496
    v_mfma_f32_16x16x32_bf16 v[64:67], v[172:175], a[24:27], v[64:67]
    ds_read_b64_tr_b16 v[170:171], v17 offset:18080
    v_mfma_f32_16x16x32_bf16 v[68:71], v[172:175], a[28:31], v[68:71]
    ds_read_b64_tr_b16 v[172:173], v17 offset:14528
    v_mfma_f32_16x16x32_bf16 v[80:83], v[176:179], a[24:27], v[80:83]
    ds_read_b64_tr_b16 v[174:175], v17 offset:18112
    s_add_u32 m0, s16, 4096
    s_nop 0
    buffer_load_dwordx4 v12, s[8:11], s17 offen offset:0 lds
    v_mfma_f32_16x16x32_bf16 v[84:87], v[176:179], a[28:31], v[84:87]
    ds_read_b64_tr_b16 v[176:177], v17 offset:14560
    v_mfma_f32_16x16x32_bf16 v[96:99], v[180:183], a[24:27], v[96:99]
    ds_read_b64_tr_b16 v[178:179], v17 offset:18144
    v_mfma_f32_16x16x32_bf16 v[100:103], v[180:183], a[28:31], v[100:103]
    ds_read_b64_tr_b16 v[180:181], v17 offset:14592
    v_mfma_f32_16x16x32_bf16 v[112:115], v[184:187], a[24:27], v[112:115]
    ds_read_b64_tr_b16 v[182:183], v17 offset:18176
    buffer_load_dwordx4 v13, s[8:11], s17 offen offset:1024 lds
    v_mfma_f32_16x16x32_bf16 v[116:119], v[184:187], a[28:31], v[116:119]
    ds_read_b64_tr_b16 v[184:185], v17 offset:14624
    v_mfma_f32_16x16x32_bf16 v[128:131], v[188:191], a[24:27], v[128:131]
    ds_read_b64_tr_b16 v[186:187], v17 offset:18208
    v_mfma_f32_16x16x32_bf16 v[132:135], v[188:191], a[28:31], v[132:135]
    ds_read_b64_tr_b16 v[188:189], v17 offset:14656
    ds_read_b64_tr_b16 v[190:191], v17 offset:18240
    s_waitcnt vmcnt(28) lgkmcnt(14)
    v_mfma_f32_16x16x32_bf16 v[24:27], v[136:139], a[32:35], v[24:27]
    buffer_load_dwordx4 a[224:227], v3, s[36:39], s15 offen offset:0 sc1
    v_mfma_f32_16x16x32_bf16 v[28:31], v[136:139], a[36:39], v[28:31]
    ds_read_b64_tr_b16 v[136:137], v17 offset:7168
    v_mfma_f32_16x16x32_bf16 v[40:43], v[140:143], a[32:35], v[40:43]
    ds_read_b64_tr_b16 v[138:139], v17 offset:10752
    buffer_load_dwordx4 v14, s[8:11], s17 offen offset:2048 lds
    s_add_u32 s17, s17, 229376
    buffer_load_dwordx4 a[228:231], v3, s[36:39], s15 offen offset:1024 sc1
    v_mfma_f32_16x16x32_bf16 v[44:47], v[140:143], a[36:39], v[44:47]
    ds_read_b64_tr_b16 v[140:141], v17 offset:7200
    v_mfma_f32_16x16x32_bf16 v[56:59], v[144:147], a[32:35], v[56:59]
    ds_read_b64_tr_b16 v[142:143], v17 offset:10784
    v_mfma_f32_16x16x32_bf16 v[60:63], v[144:147], a[36:39], v[60:63]
    ds_read_b64_tr_b16 v[144:145], v17 offset:7232
    v_mfma_f32_16x16x32_bf16 v[72:75], v[148:151], a[32:35], v[72:75]
    ds_read_b64_tr_b16 v[146:147], v17 offset:10816
    v_mfma_f32_16x16x32_bf16 v[76:79], v[148:151], a[36:39], v[76:79]
    ds_read_b64_tr_b16 v[148:149], v17 offset:7264
    v_mfma_f32_16x16x32_bf16 v[88:91], v[152:155], a[32:35], v[88:91]
    ds_read_b64_tr_b16 v[150:151], v17 offset:10848
    v_mfma_f32_16x16x32_bf16 v[92:95], v[152:155], a[36:39], v[92:95]
    ds_read_b64_tr_b16 v[152:153], v17 offset:7296
    v_mfma_f32_16x16x32_bf16 v[104:107], v[156:159], a[32:35], v[104:107]
    ds_read_b64_tr_b16 v[154:155], v17 offset:10880
    v_mfma_f32_16x16x32_bf16 v[108:111], v[156:159], a[36:39], v[108:111]
    ds_read_b64_tr_b16 v[156:157], v17 offset:7328
    v_mfma_f32_16x16x32_bf16 v[120:123], v[160:163], a[32:35], v[120:123]
    ds_read_b64_tr_b16 v[158:159], v17 offset:10912
    v_mfma_f32_16x16x32_bf16 v[124:127], v[160:163], a[36:39], v[124:127]
    ds_read_b64_tr_b16 v[160:161], v17 offset:7360
    ds_read_b64_tr_b16 v[162:163], v17 offset:10944
    s_waitcnt lgkmcnt(14)
    v_mfma_f32_16x16x32_bf16 v[32:35], v[164:167], a[32:35], v[32:35]
    buffer_load_dwordx4 a[232:235], v3, s[36:39], s15 offen offset:2048 sc1
    v_mfma_f32_16x16x32_bf16 v[36:39], v[164:167], a[36:39], v[36:39]
    ds_read_b64_tr_b16 v[164:165], v17 offset:21632
    v_mfma_f32_16x16x32_bf16 v[48:51], v[168:171], a[32:35], v[48:51]
    ds_read_b64_tr_b16 v[166:167], v17 offset:25216
    v_mfma_f32_16x16x32_bf16 v[52:55], v[168:171], a[36:39], v[52:55]
    ds_read_b64_tr_b16 v[168:169], v17 offset:21664
    v_mfma_f32_16x16x32_bf16 v[64:67], v[172:175], a[32:35], v[64:67]
    ds_read_b64_tr_b16 v[170:171], v17 offset:25248
    v_mfma_f32_16x16x32_bf16 v[68:71], v[172:175], a[36:39], v[68:71]
    ds_read_b64_tr_b16 v[172:173], v17 offset:21696
    v_mfma_f32_16x16x32_bf16 v[80:83], v[176:179], a[32:35], v[80:83]
    ds_read_b64_tr_b16 v[174:175], v17 offset:25280
    v_mfma_f32_16x16x32_bf16 v[84:87], v[176:179], a[36:39], v[84:87]
    ds_read_b64_tr_b16 v[176:177], v17 offset:21728
    v_mfma_f32_16x16x32_bf16 v[96:99], v[180:183], a[32:35], v[96:99]
    ds_read_b64_tr_b16 v[178:179], v17 offset:25312
    v_mfma_f32_16x16x32_bf16 v[100:103], v[180:183], a[36:39], v[100:103]
    ds_read_b64_tr_b16 v[180:181], v17 offset:21760
    v_mfma_f32_16x16x32_bf16 v[112:115], v[184:187], a[32:35], v[112:115]
    ds_read_b64_tr_b16 v[182:183], v17 offset:25344
    v_mfma_f32_16x16x32_bf16 v[116:119], v[184:187], a[36:39], v[116:119]
    ds_read_b64_tr_b16 v[184:185], v17 offset:21792
    v_mfma_f32_16x16x32_bf16 v[128:131], v[188:191], a[32:35], v[128:131]
    ds_read_b64_tr_b16 v[186:187], v17 offset:25376
    v_mfma_f32_16x16x32_bf16 v[132:135], v[188:191], a[36:39], v[132:135]
    ds_read_b64_tr_b16 v[188:189], v17 offset:21824
    ds_read_b64_tr_b16 v[190:191], v17 offset:25408
    s_waitcnt vmcnt(30) lgkmcnt(14)
    s_barrier
    v_mfma_f32_16x16x32_bf16 v[24:27], v[136:139], a[40:43], v[24:27]
    buffer_load_dwordx4 a[236:239], v3, s[36:39], s15 offen offset:3072 sc1
    s_add_u32 s15, s15, 4096
    v_mfma_f32_16x16x32_bf16 v[28:31], v[136:139], a[44:47], v[28:31]
    ds_read_b64_tr_b16 v[136:137], v18 offset:0
    v_mfma_f32_16x16x32_bf16 v[40:43], v[140:143], a[40:43], v[40:43]
    ds_read_b64_tr_b16 v[138:139], v18 offset:3584
    s_add_u32 m0, s16, 28928
    s_nop 0
    buffer_load_dwordx4 v8, s[8:11], s17 offen offset:0 lds
    v_mfma_f32_16x16x32_bf16 v[44:47], v[140:143], a[44:47], v[44:47]
    ds_read_b64_tr_b16 v[140:141], v18 offset:32
    v_mfma_f32_16x16x32_bf16 v[56:59], v[144:147], a[40:43], v[56:59]
    ds_read_b64_tr_b16 v[142:143], v18 offset:3616
    buffer_load_dwordx4 a[240:243], v3, s[36:39], s15 offen offset:0 sc1
    v_mfma_f32_16x16x32_bf16 v[60:63], v[144:147], a[44:47], v[60:63]
    ds_read_b64_tr_b16 v[144:145], v18 offset:64
    v_mfma_f32_16x16x32_bf16 v[72:75], v[148:151], a[40:43], v[72:75]
    ds_read_b64_tr_b16 v[146:147], v18 offset:3648
    buffer_load_dwordx4 v9, s[8:11], s17 offen offset:1024 lds
    v_mfma_f32_16x16x32_bf16 v[76:79], v[148:151], a[44:47], v[76:79]
    ds_read_b64_tr_b16 v[148:149], v18 offset:96
    v_mfma_f32_16x16x32_bf16 v[88:91], v[152:155], a[40:43], v[88:91]
    ds_read_b64_tr_b16 v[150:151], v18 offset:3680
    v_mfma_f32_16x16x32_bf16 v[92:95], v[152:155], a[44:47], v[92:95]
    ds_read_b64_tr_b16 v[152:153], v18 offset:128
    v_mfma_f32_16x16x32_bf16 v[104:107], v[156:159], a[40:43], v[104:107]
    ds_read_b64_tr_b16 v[154:155], v18 offset:3712
    buffer_load_dwordx4 v10, s[8:11], s17 offen offset:2048 lds
    v_mfma_f32_16x16x32_bf16 v[108:111], v[156:159], a[44:47], v[108:111]
    ds_read_b64_tr_b16 v[156:157], v18 offset:160
    v_mfma_f32_16x16x32_bf16 v[120:123], v[160:163], a[40:43], v[120:123]
    ds_read_b64_tr_b16 v[158:159], v18 offset:3744
    v_mfma_f32_16x16x32_bf16 v[124:127], v[160:163], a[44:47], v[124:127]
    ds_read_b64_tr_b16 v[160:161], v18 offset:192
    ds_read_b64_tr_b16 v[162:163], v18 offset:3776
    s_waitcnt lgkmcnt(14)
    v_mfma_f32_16x16x32_bf16 v[32:35], v[164:167], a[40:43], v[32:35]
    buffer_load_dwordx4 a[244:247], v3, s[36:39], s15 offen offset:1024 sc1
    v_mfma_f32_16x16x32_bf16 v[36:39], v[164:167], a[44:47], v[36:39]
    ds_read_b64_tr_b16 v[164:165], v18 offset:14464
    v_mfma_f32_16x16x32_bf16 v[48:51], v[168:171], a[40:43], v[48:51]
    ds_read_b64_tr_b16 v[166:167], v18 offset:18048
    buffer_load_dwordx4 v11, s[8:11], s17 offen offset:3072 lds
    v_mfma_f32_16x16x32_bf16 v[52:55], v[168:171], a[44:47], v[52:55]
    ds_read_b64_tr_b16 v[168:169], v18 offset:14496
    v_mfma_f32_16x16x32_bf16 v[64:67], v[172:175], a[40:43], v[64:67]
    ds_read_b64_tr_b16 v[170:171], v18 offset:18080
    v_mfma_f32_16x16x32_bf16 v[68:71], v[172:175], a[44:47], v[68:71]
    ds_read_b64_tr_b16 v[172:173], v18 offset:14528
    v_mfma_f32_16x16x32_bf16 v[80:83], v[176:179], a[40:43], v[80:83]
    ds_read_b64_tr_b16 v[174:175], v18 offset:18112
    s_add_u32 m0, s16, 33024
    s_nop 0
    buffer_load_dwordx4 v12, s[8:11], s17 offen offset:0 lds
    v_mfma_f32_16x16x32_bf16 v[84:87], v[176:179], a[44:47], v[84:87]
    ds_read_b64_tr_b16 v[176:177], v18 offset:14560
    v_mfma_f32_16x16x32_bf16 v[96:99], v[180:183], a[40:43], v[96:99]
    ds_read_b64_tr_b16 v[178:179], v18 offset:18144
    v_mfma_f32_16x16x32_bf16 v[100:103], v[180:183], a[44:47], v[100:103]
    ds_read_b64_tr_b16 v[180:181], v18 offset:14592
    v_mfma_f32_16x16x32_bf16 v[112:115], v[184:187], a[40:43], v[112:115]
    ds_read_b64_tr_b16 v[182:183], v18 offset:18176
    buffer_load_dwordx4 v13, s[8:11], s17 offen offset:1024 lds
    v_mfma_f32_16x16x32_bf16 v[116:119], v[184:187], a[44:47], v[116:119]
    ds_read_b64_tr_b16 v[184:185], v18 offset:14624
    v_mfma_f32_16x16x32_bf16 v[128:131], v[188:191], a[40:43], v[128:131]
    ds_read_b64_tr_b16 v[186:187], v18 offset:18208
    v_mfma_f32_16x16x32_bf16 v[132:135], v[188:191], a[44:47], v[132:135]
    ds_read_b64_tr_b16 v[188:189], v18 offset:14656
    ds_read_b64_tr_b16 v[190:191], v18 offset:18240
    s_waitcnt vmcnt(37) lgkmcnt(14)
    v_mfma_f32_16x16x32_bf16 v[24:27], v[136:139], a[48:51], v[24:27]
    buffer_load_dwordx4 a[248:251], v3, s[36:39], s15 offen offset:2048 sc1
    v_mfma_f32_16x16x32_bf16 v[28:31], v[136:139], a[52:55], v[28:31]
    ds_read_b64_tr_b16 v[136:137], v18 offset:7168
    v_mfma_f32_16x16x32_bf16 v[40:43], v[140:143], a[48:51], v[40:43]
    ds_read_b64_tr_b16 v[138:139], v18 offset:10752
    buffer_load_dwordx4 v14, s[8:11], s17 offen offset:2048 lds
    s_add_u32 s17, s17, 229376
    v_mfma_f32_16x16x32_bf16 v[44:47], v[140:143], a[52:55], v[44:47]
    ds_read_b64_tr_b16 v[140:141], v18 offset:7200
    v_mfma_f32_16x16x32_bf16 v[56:59], v[144:147], a[48:51], v[56:59]
    ds_read_b64_tr_b16 v[142:143], v18 offset:10784
    v_mfma_f32_16x16x32_bf16 v[60:63], v[144:147], a[52:55], v[60:63]
    ds_read_b64_tr_b16 v[144:145], v18 offset:7232
    v_mfma_f32_16x16x32_bf16 v[72:75], v[148:151], a[48:51], v[72:75]
    ds_read_b64_tr_b16 v[146:147], v18 offset:10816
    v_mfma_f32_16x16x32_bf16 v[76:79], v[148:151], a[52:55], v[76:79]
    ds_read_b64_tr_b16 v[148:149], v18 offset:7264
    v_mfma_f32_16x16x32_bf16 v[88:91], v[152:155], a[48:51], v[88:91]
    ds_read_b64_tr_b16 v[150:151], v18 offset:10848
    v_mfma_f32_16x16x32_bf16 v[92:95], v[152:155], a[52:55], v[92:95]
    ds_read_b64_tr_b16 v[152:153], v18 offset:7296
    v_mfma_f32_16x16x32_bf16 v[104:107], v[156:159], a[48:51], v[104:107]
    ds_read_b64_tr_b16 v[154:155], v18 offset:10880
    v_mfma_f32_16x16x32_bf16 v[108:111], v[156:159], a[52:55], v[108:111]
    ds_read_b64_tr_b16 v[156:157], v18 offset:7328
    v_mfma_f32_16x16x32_bf16 v[120:123], v[160:163], a[48:51], v[120:123]
    ds_read_b64_tr_b16 v[158:159], v18 offset:10912
    v_mfma_f32_16x16x32_bf16 v[124:127], v[160:163], a[52:55], v[124:127]
    ds_read_b64_tr_b16 v[160:161], v18 offset:7360
    ds_read_b64_tr_b16 v[162:163], v18 offset:10944
    s_waitcnt lgkmcnt(14)
    v_mfma_f32_16x16x32_bf16 v[32:35], v[164:167], a[48:51], v[32:35]
    buffer_load_dwordx4 a[252:255], v3, s[36:39], s15 offen offset:3072 sc1
    s_add_u32 s15, s15, 4096
    v_mfma_f32_16x16x32_bf16 v[36:39], v[164:167], a[52:55], v[36:39]
    ds_read_b64_tr_b16 v[164:165], v18 offset:21632
    v_mfma_f32_16x16x32_bf16 v[48:51], v[168:171], a[48:51], v[48:51]
    ds_read_b64_tr_b16 v[166:167], v18 offset:25216
    buffer_load_dwordx4 v[192:195], v3, s[36:39], s15 offen offset:0 sc1
    v_mfma_f32_16x16x32_bf16 v[52:55], v[168:171], a[52:55], v[52:55]
    ds_read_b64_tr_b16 v[168:169], v18 offset:21664
    v_mfma_f32_16x16x32_bf16 v[64:67], v[172:175], a[48:51], v[64:67]
    ds_read_b64_tr_b16 v[170:171], v18 offset:25248
    v_mfma_f32_16x16x32_bf16 v[68:71], v[172:175], a[52:55], v[68:71]
    ds_read_b64_tr_b16 v[172:173], v18 offset:21696
    v_mfma_f32_16x16x32_bf16 v[80:83], v[176:179], a[48:51], v[80:83]
    ds_read_b64_tr_b16 v[174:175], v18 offset:25280
    v_mfma_f32_16x16x32_bf16 v[84:87], v[176:179], a[52:55], v[84:87]
    ds_read_b64_tr_b16 v[176:177], v18 offset:21728
    v_mfma_f32_16x16x32_bf16 v[96:99], v[180:183], a[48:51], v[96:99]
    ds_read_b64_tr_b16 v[178:179], v18 offset:25312
    v_mfma_f32_16x16x32_bf16 v[100:103], v[180:183], a[52:55], v[100:103]
    ds_read_b64_tr_b16 v[180:181], v18 offset:21760
    v_mfma_f32_16x16x32_bf16 v[112:115], v[184:187], a[48:51], v[112:115]
    ds_read_b64_tr_b16 v[182:183], v18 offset:25344
    v_mfma_f32_16x16x32_bf16 v[116:119], v[184:187], a[52:55], v[116:119]
    ds_read_b64_tr_b16 v[184:185], v18 offset:21792
    v_mfma_f32_16x16x32_bf16 v[128:131], v[188:191], a[48:51], v[128:131]
    ds_read_b64_tr_b16 v[186:187], v18 offset:25376
    v_mfma_f32_16x16x32_bf16 v[132:135], v[188:191], a[52:55], v[132:135]
    ds_read_b64_tr_b16 v[188:189], v18 offset:21824
    ds_read_b64_tr_b16 v[190:191], v18 offset:25408
    s_waitcnt vmcnt(39) lgkmcnt(14)
    s_barrier
    v_mfma_f32_16x16x32_bf16 v[24:27], v[136:139], a[56:59], v[24:27]
    buffer_load_dwordx4 v[196:199], v3, s[36:39], s15 offen offset:1024 sc1
    v_mfma_f32_16x16x32_bf16 v[28:31], v[136:139], a[60:63], v[28:31]
    ds_read_b64_tr_b16 v[136:137], v19 offset:0
    v_mfma_f32_16x16x32_bf16 v[40:43], v[140:143], a[56:59], v[40:43]
    ds_read_b64_tr_b16 v[138:139], v19 offset:3584
    s_add_u32 m0, s16, 57856
    s_nop 0
    buffer_load_dwordx4 v8, s[8:11], s17 offen offset:0 lds
    v_mfma_f32_16x16x32_bf16 v[44:47], v[140:143], a[60:63], v[44:47]
    ds_read_b64_tr_b16 v[140:141], v19 offset:32
    v_mfma_f32_16x16x32_bf16 v[56:59], v[144:147], a[56:59], v[56:59]
    ds_read_b64_tr_b16 v[142:143], v19 offset:3616
    v_mfma_f32_16x16x32_bf16 v[60:63], v[144:147], a[60:63], v[60:63]
    ds_read_b64_tr_b16 v[144:145], v19 offset:64
    v_mfma_f32_16x16x32_bf16 v[72:75], v[148:151], a[56:59], v[72:75]
    ds_read_b64_tr_b16 v[146:147], v19 offset:3648
    buffer_load_dwordx4 v9, s[8:11], s17 offen offset:1024 lds
    v_mfma_f32_16x16x32_bf16 v[76:79], v[148:151], a[60:63], v[76:79]
    ds_read_b64_tr_b16 v[148:149], v19 offset:96
    v_mfma_f32_16x16x32_bf16 v[88:91], v[152:155], a[56:59], v[88:91]
    ds_read_b64_tr_b16 v[150:151], v19 offset:3680
    v_mfma_f32_16x16x32_bf16 v[92:95], v[152:155], a[60:63], v[92:95]
    ds_read_b64_tr_b16 v[152:153], v19 offset:128
    v_mfma_f32_16x16x32_bf16 v[104:107], v[156:159], a[56:59], v[104:107]
    ds_read_b64_tr_b16 v[154:155], v19 offset:3712
    buffer_load_dwordx4 v10, s[8:11], s17 offen offset:2048 lds
    v_mfma_f32_16x16x32_bf16 v[108:111], v[156:159], a[60:63], v[108:111]
    ds_read_b64_tr_b16 v[156:157], v19 offset:160
    v_mfma_f32_16x16x32_bf16 v[120:123], v[160:163], a[56:59], v[120:123]
    ds_read_b64_tr_b16 v[158:159], v19 offset:3744
    v_mfma_f32_16x16x32_bf16 v[124:127], v[160:163], a[60:63], v[124:127]
    ds_read_b64_tr_b16 v[160:161], v19 offset:192
    ds_read_b64_tr_b16 v[162:163], v19 offset:3776
    s_waitcnt lgkmcnt(14)
    v_mfma_f32_16x16x32_bf16 v[32:35], v[164:167], a[56:59], v[32:35]
    buffer_load_dwordx4 v[200:203], v3, s[36:39], s15 offen offset:2048 sc1
    v_mfma_f32_16x16x32_bf16 v[36:39], v[164:167], a[60:63], v[36:39]
    ds_read_b64_tr_b16 v[164:165], v19 offset:14464
    v_mfma_f32_16x16x32_bf16 v[48:51], v[168:171], a[56:59], v[48:51]
    ds_read_b64_tr_b16 v[166:167], v19 offset:18048
    buffer_load_dwordx4 v11, s[8:11], s17 offen offset:3072 lds
    v_mfma_f32_16x16x32_bf16 v[52:55], v[168:171], a[60:63], v[52:55]
    ds_read_b64_tr_b16 v[168:169], v19 offset:14496
    v_mfma_f32_16x16x32_bf16 v[64:67], v[172:175], a[56:59], v[64:67]
    ds_read_b64_tr_b16 v[170:171], v19 offset:18080
    buffer_load_dwordx4 v[204:207], v3, s[36:39], s15 offen offset:3072 sc1
    s_add_u32 s15, s15, 4096
    v_mfma_f32_16x16x32_bf16 v[68:71], v[172:175], a[60:63], v[68:71]
    ds_read_b64_tr_b16 v[172:173], v19 offset:14528
    v_mfma_f32_16x16x32_bf16 v[80:83], v[176:179], a[56:59], v[80:83]
    ds_read_b64_tr_b16 v[174:175], v19 offset:18112
    s_add_u32 m0, s16, 61952
    s_nop 0
    buffer_load_dwordx4 v12, s[8:11], s17 offen offset:0 lds
    v_mfma_f32_16x16x32_bf16 v[84:87], v[176:179], a[60:63], v[84:87]
    ds_read_b64_tr_b16 v[176:177], v19 offset:14560
    v_mfma_f32_16x16x32_bf16 v[96:99], v[180:183], a[56:59], v[96:99]
    ds_read_b64_tr_b16 v[178:179], v19 offset:18144
    v_mfma_f32_16x16x32_bf16 v[100:103], v[180:183], a[60:63], v[100:103]
    ds_read_b64_tr_b16 v[180:181], v19 offset:14592
    v_mfma_f32_16x16x32_bf16 v[112:115], v[184:187], a[56:59], v[112:115]
    ds_read_b64_tr_b16 v[182:183], v19 offset:18176
    buffer_load_dwordx4 v13, s[8:11], s17 offen offset:1024 lds
    v_mfma_f32_16x16x32_bf16 v[116:119], v[184:187], a[60:63], v[116:119]
    ds_read_b64_tr_b16 v[184:185], v19 offset:14624
    v_mfma_f32_16x16x32_bf16 v[128:131], v[188:191], a[56:59], v[128:131]
    ds_read_b64_tr_b16 v[186:187], v19 offset:18208
    v_mfma_f32_16x16x32_bf16 v[132:135], v[188:191], a[60:63], v[132:135]
    ds_read_b64_tr_b16 v[188:189], v19 offset:14656
    ds_read_b64_tr_b16 v[190:191], v19 offset:18240
    s_waitcnt vmcnt(46) lgkmcnt(14)
    v_mfma_f32_16x16x32_bf16 v[24:27], v[136:139], a[64:67], v[24:27]
    buffer_load_dwordx4 v[208:211], v3, s[36:39], s15 offen offset:0 sc1
    v_mfma_f32_16x16x32_bf16 v[28:31], v[136:139], a[68:71], v[28:31]
    ds_read_b64_tr_b16 v[136:137], v19 offset:7168
    v_mfma_f32_16x16x32_bf16 v[40:43], v[140:143], a[64:67], v[40:43]
    ds_read_b64_tr_b16 v[138:139], v19 offset:10752
    buffer_load_dwordx4 v14, s[8:11], s17 offen offset:2048 lds
    s_add_u32 s17, s17, 229376
    v_mfma_f32_16x16x32_bf16 v[44:47], v[140:143], a[68:71], v[44:47]
    ds_read_b64_tr_b16 v[140:141], v19 offset:7200
    v_mfma_f32_16x16x32_bf16 v[56:59], v[144:147], a[64:67], v[56:59]
    ds_read_b64_tr_b16 v[142:143], v19 offset:10784
    v_mfma_f32_16x16x32_bf16 v[60:63], v[144:147], a[68:71], v[60:63]
    ds_read_b64_tr_b16 v[144:145], v19 offset:7232
    v_mfma_f32_16x16x32_bf16 v[72:75], v[148:151], a[64:67], v[72:75]
    ds_read_b64_tr_b16 v[146:147], v19 offset:10816
    v_mfma_f32_16x16x32_bf16 v[76:79], v[148:151], a[68:71], v[76:79]
    ds_read_b64_tr_b16 v[148:149], v19 offset:7264
    v_mfma_f32_16x16x32_bf16 v[88:91], v[152:155], a[64:67], v[88:91]
    ds_read_b64_tr_b16 v[150:151], v19 offset:10848
    v_mfma_f32_16x16x32_bf16 v[92:95], v[152:155], a[68:71], v[92:95]
    ds_read_b64_tr_b16 v[152:153], v19 offset:7296
    v_mfma_f32_16x16x32_bf16 v[104:107], v[156:159], a[64:67], v[104:107]
    ds_read_b64_tr_b16 v[154:155], v19 offset:10880
    v_mfma_f32_16x16x32_bf16 v[108:111], v[156:159], a[68:71], v[108:111]
    ds_read_b64_tr_b16 v[156:157], v19 offset:7328
    v_mfma_f32_16x16x32_bf16 v[120:123], v[160:163], a[64:67], v[120:123]
    ds_read_b64_tr_b16 v[158:159], v19 offset:10912
    v_mfma_f32_16x16x32_bf16 v[124:127], v[160:163], a[68:71], v[124:127]
    ds_read_b64_tr_b16 v[160:161], v19 offset:7360
    ds_read_b64_tr_b16 v[162:163], v19 offset:10944
    s_waitcnt lgkmcnt(14)
    v_mfma_f32_16x16x32_bf16 v[32:35], v[164:167], a[64:67], v[32:35]
    buffer_load_dwordx4 v[212:215], v3, s[36:39], s15 offen offset:1024 sc1
    v_mfma_f32_16x16x32_bf16 v[36:39], v[164:167], a[68:71], v[36:39]
    ds_read_b64_tr_b16 v[164:165], v19 offset:21632
    v_mfma_f32_16x16x32_bf16 v[48:51], v[168:171], a[64:67], v[48:51]
    ds_read_b64_tr_b16 v[166:167], v19 offset:25216
    v_mfma_f32_16x16x32_bf16 v[52:55], v[168:171], a[68:71], v[52:55]
    ds_read_b64_tr_b16 v[168:169], v19 offset:21664
    v_mfma_f32_16x16x32_bf16 v[64:67], v[172:175], a[64:67], v[64:67]
    ds_read_b64_tr_b16 v[170:171], v19 offset:25248
    v_mfma_f32_16x16x32_bf16 v[68:71], v[172:175], a[68:71], v[68:71]
    ds_read_b64_tr_b16 v[172:173], v19 offset:21696
    v_mfma_f32_16x16x32_bf16 v[80:83], v[176:179], a[64:67], v[80:83]
    ds_read_b64_tr_b16 v[174:175], v19 offset:25280
    v_mfma_f32_16x16x32_bf16 v[84:87], v[176:179], a[68:71], v[84:87]
    ds_read_b64_tr_b16 v[176:177], v19 offset:21728
    v_mfma_f32_16x16x32_bf16 v[96:99], v[180:183], a[64:67], v[96:99]
    ds_read_b64_tr_b16 v[178:179], v19 offset:25312
    v_mfma_f32_16x16x32_bf16 v[100:103], v[180:183], a[68:71], v[100:103]
    ds_read_b64_tr_b16 v[180:181], v19 offset:21760
    v_mfma_f32_16x16x32_bf16 v[112:115], v[184:187], a[64:67], v[112:115]
    ds_read_b64_tr_b16 v[182:183], v19 offset:25344
    v_mfma_f32_16x16x32_bf16 v[116:119], v[184:187], a[68:71], v[116:119]
    ds_read_b64_tr_b16 v[184:185], v19 offset:21792
    v_mfma_f32_16x16x32_bf16 v[128:131], v[188:191], a[64:67], v[128:131]
    ds_read_b64_tr_b16 v[186:187], v19 offset:25376
    v_mfma_f32_16x16x32_bf16 v[132:135], v[188:191], a[68:71], v[132:135]
    ds_read_b64_tr_b16 v[188:189], v19 offset:21824
    ds_read_b64_tr_b16 v[190:191], v19 offset:25408
    s_waitcnt vmcnt(27) lgkmcnt(14)
    s_barrier
    v_mfma_f32_16x16x32_bf16 v[24:27], v[136:139], a[72:75], v[24:27]
    buffer_load_dwordx4 v[216:219], v3, s[36:39], s15 offen offset:2048 sc1
    v_mfma_f32_16x16x32_bf16 v[28:31], v[136:139], a[76:79], v[28:31]
    ds_read_b64_tr_b16 v[136:137], v15 offset:0
    v_mfma_f32_16x16x32_bf16 v[40:43], v[140:143], a[72:75], v[40:43]
    ds_read_b64_tr_b16 v[138:139], v15 offset:3584
    buffer_load_dwordx4 v[220:223], v3, s[36:39], s15 offen offset:3072 sc1
    s_add_u32 s15, s15, 4096
    v_mfma_f32_16x16x32_bf16 v[44:47], v[140:143], a[76:79], v[44:47]
    ds_read_b64_tr_b16 v[140:141], v15 offset:32
    v_mfma_f32_16x16x32_bf16 v[56:59], v[144:147], a[72:75], v[56:59]
    ds_read_b64_tr_b16 v[142:143], v15 offset:3616
    v_mfma_f32_16x16x32_bf16 v[60:63], v[144:147], a[76:79], v[60:63]
    ds_read_b64_tr_b16 v[144:145], v15 offset:64
    v_mfma_f32_16x16x32_bf16 v[72:75], v[148:151], a[72:75], v[72:75]
    ds_read_b64_tr_b16 v[146:147], v15 offset:3648
    v_mfma_f32_16x16x32_bf16 v[76:79], v[148:151], a[76:79], v[76:79]
    ds_read_b64_tr_b16 v[148:149], v15 offset:96
    v_mfma_f32_16x16x32_bf16 v[88:91], v[152:155], a[72:75], v[88:91]
    ds_read_b64_tr_b16 v[150:151], v15 offset:3680
    v_mfma_f32_16x16x32_bf16 v[92:95], v[152:155], a[76:79], v[92:95]
    ds_read_b64_tr_b16 v[152:153], v15 offset:128
    v_mfma_f32_16x16x32_bf16 v[104:107], v[156:159], a[72:75], v[104:107]
    ds_read_b64_tr_b16 v[154:155], v15 offset:3712
    v_mfma_f32_16x16x32_bf16 v[108:111], v[156:159], a[76:79], v[108:111]
    ds_read_b64_tr_b16 v[156:157], v15 offset:160
    v_mfma_f32_16x16x32_bf16 v[120:123], v[160:163], a[72:75], v[120:123]
    ds_read_b64_tr_b16 v[158:159], v15 offset:3744
    v_mfma_f32_16x16x32_bf16 v[124:127], v[160:163], a[76:79], v[124:127]
    ds_read_b64_tr_b16 v[160:161], v15 offset:192
    ds_read_b64_tr_b16 v[162:163], v15 offset:3776
    s_waitcnt lgkmcnt(14)
    v_mfma_f32_16x16x32_bf16 v[32:35], v[164:167], a[72:75], v[32:35]
    buffer_load_dwordx4 v[224:227], v3, s[36:39], s15 offen offset:0 sc1
    v_mfma_f32_16x16x32_bf16 v[36:39], v[164:167], a[76:79], v[36:39]
    ds_read_b64_tr_b16 v[164:165], v15 offset:14464
    v_mfma_f32_16x16x32_bf16 v[48:51], v[168:171], a[72:75], v[48:51]
    ds_read_b64_tr_b16 v[166:167], v15 offset:18048
    v_mfma_f32_16x16x32_bf16 v[52:55], v[168:171], a[76:79], v[52:55]
    ds_read_b64_tr_b16 v[168:169], v15 offset:14496
    v_mfma_f32_16x16x32_bf16 v[64:67], v[172:175], a[72:75], v[64:67]
    ds_read_b64_tr_b16 v[170:171], v15 offset:18080
    v_mfma_f32_16x16x32_bf16 v[68:71], v[172:175], a[76:79], v[68:71]
    ds_read_b64_tr_b16 v[172:173], v15 offset:14528
    v_mfma_f32_16x16x32_bf16 v[80:83], v[176:179], a[72:75], v[80:83]
    ds_read_b64_tr_b16 v[174:175], v15 offset:18112
    v_mfma_f32_16x16x32_bf16 v[84:87], v[176:179], a[76:79], v[84:87]
    ds_read_b64_tr_b16 v[176:177], v15 offset:14560
    v_mfma_f32_16x16x32_bf16 v[96:99], v[180:183], a[72:75], v[96:99]
    ds_read_b64_tr_b16 v[178:179], v15 offset:18144
    v_mfma_f32_16x16x32_bf16 v[100:103], v[180:183], a[76:79], v[100:103]
    ds_read_b64_tr_b16 v[180:181], v15 offset:14592
    v_mfma_f32_16x16x32_bf16 v[112:115], v[184:187], a[72:75], v[112:115]
    ds_read_b64_tr_b16 v[182:183], v15 offset:18176
    v_mfma_f32_16x16x32_bf16 v[116:119], v[184:187], a[76:79], v[116:119]
    ds_read_b64_tr_b16 v[184:185], v15 offset:14624
    v_mfma_f32_16x16x32_bf16 v[128:131], v[188:191], a[72:75], v[128:131]
    ds_read_b64_tr_b16 v[186:187], v15 offset:18208
    v_mfma_f32_16x16x32_bf16 v[132:135], v[188:191], a[76:79], v[132:135]
    ds_read_b64_tr_b16 v[188:189], v15 offset:14656
    ds_read_b64_tr_b16 v[190:191], v15 offset:18240
    s_waitcnt lgkmcnt(14)
    v_mfma_f32_16x16x32_bf16 v[24:27], v[136:139], a[80:83], v[24:27]
    buffer_load_dwordx4 v[228:231], v3, s[36:39], s15 offen offset:1024 sc1
    v_mfma_f32_16x16x32_bf16 v[28:31], v[136:139], a[84:87], v[28:31]
    ds_read_b64_tr_b16 v[136:137], v15 offset:7168
    v_mfma_f32_16x16x32_bf16 v[40:43], v[140:143], a[80:83], v[40:43]
    ds_read_b64_tr_b16 v[138:139], v15 offset:10752
    buffer_load_dwordx4 v[232:235], v3, s[36:39], s15 offen offset:2048 sc1
    v_mfma_f32_16x16x32_bf16 v[44:47], v[140:143], a[84:87], v[44:47]
    ds_read_b64_tr_b16 v[140:141], v15 offset:7200
    v_mfma_f32_16x16x32_bf16 v[56:59], v[144:147], a[80:83], v[56:59]
    ds_read_b64_tr_b16 v[142:143], v15 offset:10784
    v_mfma_f32_16x16x32_bf16 v[60:63], v[144:147], a[84:87], v[60:63]
    ds_read_b64_tr_b16 v[144:145], v15 offset:7232
    v_mfma_f32_16x16x32_bf16 v[72:75], v[148:151], a[80:83], v[72:75]
    ds_read_b64_tr_b16 v[146:147], v15 offset:10816
    v_mfma_f32_16x16x32_bf16 v[76:79], v[148:151], a[84:87], v[76:79]
    ds_read_b64_tr_b16 v[148:149], v15 offset:7264
    v_mfma_f32_16x16x32_bf16 v[88:91], v[152:155], a[80:83], v[88:91]
    ds_read_b64_tr_b16 v[150:151], v15 offset:10848
    v_mfma_f32_16x16x32_bf16 v[92:95], v[152:155], a[84:87], v[92:95]
    ds_read_b64_tr_b16 v[152:153], v15 offset:7296
    v_mfma_f32_16x16x32_bf16 v[104:107], v[156:159], a[80:83], v[104:107]
    ds_read_b64_tr_b16 v[154:155], v15 offset:10880
    v_mfma_f32_16x16x32_bf16 v[108:111], v[156:159], a[84:87], v[108:111]
    ds_read_b64_tr_b16 v[156:157], v15 offset:7328
    v_mfma_f32_16x16x32_bf16 v[120:123], v[160:163], a[80:83], v[120:123]
    ds_read_b64_tr_b16 v[158:159], v15 offset:10912
    v_mfma_f32_16x16x32_bf16 v[124:127], v[160:163], a[84:87], v[124:127]
    ds_read_b64_tr_b16 v[160:161], v15 offset:7360
    ds_read_b64_tr_b16 v[162:163], v15 offset:10944
    s_waitcnt lgkmcnt(14)
    v_mfma_f32_16x16x32_bf16 v[32:35], v[164:167], a[80:83], v[32:35]
    buffer_load_dwordx4 v[236:239], v3, s[36:39], s15 offen offset:3072 sc1
    s_add_u32 s15, s15, 4096
    v_mfma_f32_16x16x32_bf16 v[36:39], v[164:167], a[84:87], v[36:39]
    ds_read_b64_tr_b16 v[164:165], v15 offset:21632
    v_mfma_f32_16x16x32_bf16 v[48:51], v[168:171], a[80:83], v[48:51]
    ds_read_b64_tr_b16 v[166:167], v15 offset:25216
    v_mfma_f32_16x16x32_bf16 v[52:55], v[168:171], a[84:87], v[52:55]
    ds_read_b64_tr_b16 v[168:169], v15 offset:21664
    v_mfma_f32_16x16x32_bf16 v[64:67], v[172:175], a[80:83], v[64:67]
    ds_read_b64_tr_b16 v[170:171], v15 offset:25248
    v_mfma_f32_16x16x32_bf16 v[68:71], v[172:175], a[84:87], v[68:71]
    ds_read_b64_tr_b16 v[172:173], v15 offset:21696
    v_mfma_f32_16x16x32_bf16 v[80:83], v[176:179], a[80:83], v[80:83]
    ds_read_b64_tr_b16 v[174:175], v15 offset:25280
    v_mfma_f32_16x16x32_bf16 v[84:87], v[176:179], a[84:87], v[84:87]
    ds_read_b64_tr_b16 v[176:177], v15 offset:21728
    v_mfma_f32_16x16x32_bf16 v[96:99], v[180:183], a[80:83], v[96:99]
    ds_read_b64_tr_b16 v[178:179], v15 offset:25312
    v_mfma_f32_16x16x32_bf16 v[100:103], v[180:183], a[84:87], v[100:103]
    ds_read_b64_tr_b16 v[180:181], v15 offset:21760
    v_mfma_f32_16x16x32_bf16 v[112:115], v[184:187], a[80:83], v[112:115]
    ds_read_b64_tr_b16 v[182:183], v15 offset:25344
    v_mfma_f32_16x16x32_bf16 v[116:119], v[184:187], a[84:87], v[116:119]
    ds_read_b64_tr_b16 v[184:185], v15 offset:21792
    v_mfma_f32_16x16x32_bf16 v[128:131], v[188:191], a[80:83], v[128:131]
    ds_read_b64_tr_b16 v[186:187], v15 offset:25376
    v_mfma_f32_16x16x32_bf16 v[132:135], v[188:191], a[84:87], v[132:135]
    ds_read_b64_tr_b16 v[188:189], v15 offset:21824
    ds_read_b64_tr_b16 v[190:191], v15 offset:25408
    s_waitcnt vmcnt(20) lgkmcnt(14)
    s_barrier
    v_mfma_f32_16x16x32_bf16 v[24:27], v[136:139], a[88:91], v[24:27]
    buffer_load_dwordx4 v[240:243], v3, s[36:39], s15 offen offset:0 sc1
    v_mfma_f32_16x16x32_bf16 v[28:31], v[136:139], a[92:95], v[28:31]
    ds_read_b64_tr_b16 v[136:137], v16 offset:0
    v_mfma_f32_16x16x32_bf16 v[40:43], v[140:143], a[88:91], v[40:43]
    ds_read_b64_tr_b16 v[138:139], v16 offset:3584
    v_mfma_f32_16x16x32_bf16 v[44:47], v[140:143], a[92:95], v[44:47]
    ds_read_b64_tr_b16 v[140:141], v16 offset:32
    v_mfma_f32_16x16x32_bf16 v[56:59], v[144:147], a[88:91], v[56:59]
    ds_read_b64_tr_b16 v[142:143], v16 offset:3616
    v_mfma_f32_16x16x32_bf16 v[60:63], v[144:147], a[92:95], v[60:63]
    ds_read_b64_tr_b16 v[144:145], v16 offset:64
    v_mfma_f32_16x16x32_bf16 v[72:75], v[148:151], a[88:91], v[72:75]
    ds_read_b64_tr_b16 v[146:147], v16 offset:3648
    v_mfma_f32_16x16x32_bf16 v[76:79], v[148:151], a[92:95], v[76:79]
    ds_read_b64_tr_b16 v[148:149], v16 offset:96
    v_mfma_f32_16x16x32_bf16 v[88:91], v[152:155], a[88:91], v[88:91]
    ds_read_b64_tr_b16 v[150:151], v16 offset:3680
    v_mfma_f32_16x16x32_bf16 v[92:95], v[152:155], a[92:95], v[92:95]
    ds_read_b64_tr_b16 v[152:153], v16 offset:128
    v_mfma_f32_16x16x32_bf16 v[104:107], v[156:159], a[88:91], v[104:107]
    ds_read_b64_tr_b16 v[154:155], v16 offset:3712
    v_mfma_f32_16x16x32_bf16 v[108:111], v[156:159], a[92:95], v[108:111]
    ds_read_b64_tr_b16 v[156:157], v16 offset:160
    v_mfma_f32_16x16x32_bf16 v[120:123], v[160:163], a[88:91], v[120:123]
    ds_read_b64_tr_b16 v[158:159], v16 offset:3744
    v_mfma_f32_16x16x32_bf16 v[124:127], v[160:163], a[92:95], v[124:127]
    ds_read_b64_tr_b16 v[160:161], v16 offset:192
    ds_read_b64_tr_b16 v[162:163], v16 offset:3776
    s_waitcnt lgkmcnt(14)
    v_mfma_f32_16x16x32_bf16 v[32:35], v[164:167], a[88:91], v[32:35]
    buffer_load_dwordx4 v[244:247], v3, s[36:39], s15 offen offset:1024 sc1
    v_mfma_f32_16x16x32_bf16 v[36:39], v[164:167], a[92:95], v[36:39]
    ds_read_b64_tr_b16 v[164:165], v16 offset:14464
    v_mfma_f32_16x16x32_bf16 v[48:51], v[168:171], a[88:91], v[48:51]
    ds_read_b64_tr_b16 v[166:167], v16 offset:18048
    buffer_load_dwordx4 v[248:251], v3, s[36:39], s15 offen offset:2048 sc1
    v_mfma_f32_16x16x32_bf16 v[52:55], v[168:171], a[92:95], v[52:55]
    ds_read_b64_tr_b16 v[168:169], v16 offset:14496
    v_mfma_f32_16x16x32_bf16 v[64:67], v[172:175], a[88:91], v[64:67]
    ds_read_b64_tr_b16 v[170:171], v16 offset:18080
    v_mfma_f32_16x16x32_bf16 v[68:71], v[172:175], a[92:95], v[68:71]
    ds_read_b64_tr_b16 v[172:173], v16 offset:14528
    v_mfma_f32_16x16x32_bf16 v[80:83], v[176:179], a[88:91], v[80:83]
    ds_read_b64_tr_b16 v[174:175], v16 offset:18112
    v_mfma_f32_16x16x32_bf16 v[84:87], v[176:179], a[92:95], v[84:87]
    ds_read_b64_tr_b16 v[176:177], v16 offset:14560
    v_mfma_f32_16x16x32_bf16 v[96:99], v[180:183], a[88:91], v[96:99]
    ds_read_b64_tr_b16 v[178:179], v16 offset:18144
    v_mfma_f32_16x16x32_bf16 v[100:103], v[180:183], a[92:95], v[100:103]
    ds_read_b64_tr_b16 v[180:181], v16 offset:14592
    v_mfma_f32_16x16x32_bf16 v[112:115], v[184:187], a[88:91], v[112:115]
    ds_read_b64_tr_b16 v[182:183], v16 offset:18176
    v_mfma_f32_16x16x32_bf16 v[116:119], v[184:187], a[92:95], v[116:119]
    ds_read_b64_tr_b16 v[184:185], v16 offset:14624
    v_mfma_f32_16x16x32_bf16 v[128:131], v[188:191], a[88:91], v[128:131]
    ds_read_b64_tr_b16 v[186:187], v16 offset:18208
    v_mfma_f32_16x16x32_bf16 v[132:135], v[188:191], a[92:95], v[132:135]
    ds_read_b64_tr_b16 v[188:189], v16 offset:14656
    ds_read_b64_tr_b16 v[190:191], v16 offset:18240
    s_waitcnt lgkmcnt(14)
    v_mfma_f32_16x16x32_bf16 v[24:27], v[136:139], a[96:99], v[24:27]
    buffer_load_dwordx4 v[252:255], v3, s[36:39], s15 offen offset:3072 sc1
    s_add_u32 s15, s15, 4096
    v_mfma_f32_16x16x32_bf16 v[28:31], v[136:139], a[100:103], v[28:31]
    ds_read_b64_tr_b16 v[136:137], v16 offset:7168
    v_mfma_f32_16x16x32_bf16 v[40:43], v[140:143], a[96:99], v[40:43]
    ds_read_b64_tr_b16 v[138:139], v16 offset:10752
    v_mfma_f32_16x16x32_bf16 v[44:47], v[140:143], a[100:103], v[44:47]
    ds_read_b64_tr_b16 v[140:141], v16 offset:7200
    v_mfma_f32_16x16x32_bf16 v[56:59], v[144:147], a[96:99], v[56:59]
    ds_read_b64_tr_b16 v[142:143], v16 offset:10784
    v_mfma_f32_16x16x32_bf16 v[60:63], v[144:147], a[100:103], v[60:63]
    ds_read_b64_tr_b16 v[144:145], v16 offset:7232
    v_mfma_f32_16x16x32_bf16 v[72:75], v[148:151], a[96:99], v[72:75]
    ds_read_b64_tr_b16 v[146:147], v16 offset:10816
    v_mfma_f32_16x16x32_bf16 v[76:79], v[148:151], a[100:103], v[76:79]
    ds_read_b64_tr_b16 v[148:149], v16 offset:7264
    v_mfma_f32_16x16x32_bf16 v[88:91], v[152:155], a[96:99], v[88:91]
    ds_read_b64_tr_b16 v[150:151], v16 offset:10848
    v_mfma_f32_16x16x32_bf16 v[92:95], v[152:155], a[100:103], v[92:95]
    ds_read_b64_tr_b16 v[152:153], v16 offset:7296
    v_mfma_f32_16x16x32_bf16 v[104:107], v[156:159], a[96:99], v[104:107]
    ds_read_b64_tr_b16 v[154:155], v16 offset:10880
    v_mfma_f32_16x16x32_bf16 v[108:111], v[156:159], a[100:103], v[108:111]
    ds_read_b64_tr_b16 v[156:157], v16 offset:7328
    v_mfma_f32_16x16x32_bf16 v[120:123], v[160:163], a[96:99], v[120:123]
    ds_read_b64_tr_b16 v[158:159], v16 offset:10912
    v_mfma_f32_16x16x32_bf16 v[124:127], v[160:163], a[100:103], v[124:127]
    ds_read_b64_tr_b16 v[160:161], v16 offset:7360
    ds_read_b64_tr_b16 v[162:163], v16 offset:10944
    s_waitcnt lgkmcnt(14)
    v_mfma_f32_16x16x32_bf16 v[32:35], v[164:167], a[96:99], v[32:35]
    buffer_load_dwordx4 a[0:3], v3, s[36:39], s15 offen offset:0 sc1
    v_mfma_f32_16x16x32_bf16 v[36:39], v[164:167], a[100:103], v[36:39]
    ds_read_b64_tr_b16 v[164:165], v16 offset:21632
    v_mfma_f32_16x16x32_bf16 v[48:51], v[168:171], a[96:99], v[48:51]
    ds_read_b64_tr_b16 v[166:167], v16 offset:25216
    buffer_load_dwordx4 a[4:7], v3, s[36:39], s15 offen offset:1024 sc1
    v_mfma_f32_16x16x32_bf16 v[52:55], v[168:171], a[100:103], v[52:55]
    ds_read_b64_tr_b16 v[168:169], v16 offset:21664
    v_mfma_f32_16x16x32_bf16 v[64:67], v[172:175], a[96:99], v[64:67]
    ds_read_b64_tr_b16 v[170:171], v16 offset:25248
    v_mfma_f32_16x16x32_bf16 v[68:71], v[172:175], a[100:103], v[68:71]
    ds_read_b64_tr_b16 v[172:173], v16 offset:21696
    v_mfma_f32_16x16x32_bf16 v[80:83], v[176:179], a[96:99], v[80:83]
    ds_read_b64_tr_b16 v[174:175], v16 offset:25280
    v_mfma_f32_16x16x32_bf16 v[84:87], v[176:179], a[100:103], v[84:87]
    ds_read_b64_tr_b16 v[176:177], v16 offset:21728
    v_mfma_f32_16x16x32_bf16 v[96:99], v[180:183], a[96:99], v[96:99]
    ds_read_b64_tr_b16 v[178:179], v16 offset:25312
    v_mfma_f32_16x16x32_bf16 v[100:103], v[180:183], a[100:103], v[100:103]
    ds_read_b64_tr_b16 v[180:181], v16 offset:21760
    v_mfma_f32_16x16x32_bf16 v[112:115], v[184:187], a[96:99], v[112:115]
    ds_read_b64_tr_b16 v[182:183], v16 offset:25344
    v_mfma_f32_16x16x32_bf16 v[116:119], v[184:187], a[100:103], v[116:119]
    ds_read_b64_tr_b16 v[184:185], v16 offset:21792
    v_mfma_f32_16x16x32_bf16 v[128:131], v[188:191], a[96:99], v[128:131]
    ds_read_b64_tr_b16 v[186:187], v16 offset:25376
    v_mfma_f32_16x16x32_bf16 v[132:135], v[188:191], a[100:103], v[132:135]
    ds_read_b64_tr_b16 v[188:189], v16 offset:21824
    ds_read_b64_tr_b16 v[190:191], v16 offset:25408
    s_waitcnt vmcnt(13) lgkmcnt(14)
    s_barrier
    v_mfma_f32_16x16x32_bf16 v[24:27], v[136:139], a[104:107], v[24:27]
    buffer_load_dwordx4 a[8:11], v3, s[36:39], s15 offen offset:2048 sc1
    v_mfma_f32_16x16x32_bf16 v[28:31], v[136:139], a[108:111], v[28:31]
    ds_read_b64_tr_b16 v[136:137], v17 offset:0
    v_mfma_f32_16x16x32_bf16 v[40:43], v[140:143], a[104:107], v[40:43]
    ds_read_b64_tr_b16 v[138:139], v17 offset:3584
    v_mfma_f32_16x16x32_bf16 v[44:47], v[140:143], a[108:111], v[44:47]
    ds_read_b64_tr_b16 v[140:141], v17 offset:32
    v_mfma_f32_16x16x32_bf16 v[56:59], v[144:147], a[104:107], v[56:59]
    ds_read_b64_tr_b16 v[142:143], v17 offset:3616
    v_mfma_f32_16x16x32_bf16 v[60:63], v[144:147], a[108:111], v[60:63]
    ds_read_b64_tr_b16 v[144:145], v17 offset:64
    v_mfma_f32_16x16x32_bf16 v[72:75], v[148:151], a[104:107], v[72:75]
    ds_read_b64_tr_b16 v[146:147], v17 offset:3648
    v_mfma_f32_16x16x32_bf16 v[76:79], v[148:151], a[108:111], v[76:79]
    ds_read_b64_tr_b16 v[148:149], v17 offset:96
    v_mfma_f32_16x16x32_bf16 v[88:91], v[152:155], a[104:107], v[88:91]
    ds_read_b64_tr_b16 v[150:151], v17 offset:3680
    v_mfma_f32_16x16x32_bf16 v[92:95], v[152:155], a[108:111], v[92:95]
    ds_read_b64_tr_b16 v[152:153], v17 offset:128
    v_mfma_f32_16x16x32_bf16 v[104:107], v[156:159], a[104:107], v[104:107]
    ds_read_b64_tr_b16 v[154:155], v17 offset:3712
    v_mfma_f32_16x16x32_bf16 v[108:111], v[156:159], a[108:111], v[108:111]
    ds_read_b64_tr_b16 v[156:157], v17 offset:160
    v_mfma_f32_16x16x32_bf16 v[120:123], v[160:163], a[104:107], v[120:123]
    ds_read_b64_tr_b16 v[158:159], v17 offset:3744
    v_mfma_f32_16x16x32_bf16 v[124:127], v[160:163], a[108:111], v[124:127]
    ds_read_b64_tr_b16 v[160:161], v17 offset:192
    ds_read_b64_tr_b16 v[162:163], v17 offset:3776
    s_waitcnt lgkmcnt(14)
    v_mfma_f32_16x16x32_bf16 v[32:35], v[164:167], a[104:107], v[32:35]
    buffer_load_dwordx4 a[12:15], v3, s[36:39], s15 offen offset:3072 sc1
    s_add_u32 s15, s15, 4096
    v_mfma_f32_16x16x32_bf16 v[36:39], v[164:167], a[108:111], v[36:39]
    ds_read_b64_tr_b16 v[164:165], v17 offset:14464
    v_mfma_f32_16x16x32_bf16 v[48:51], v[168:171], a[104:107], v[48:51]
    ds_read_b64_tr_b16 v[166:167], v17 offset:18048
    v_mfma_f32_16x16x32_bf16 v[52:55], v[168:171], a[108:111], v[52:55]
    ds_read_b64_tr_b16 v[168:169], v17 offset:14496
    v_mfma_f32_16x16x32_bf16 v[64:67], v[172:175], a[104:107], v[64:67]
    ds_read_b64_tr_b16 v[170:171], v17 offset:18080
    v_mfma_f32_16x16x32_bf16 v[68:71], v[172:175], a[108:111], v[68:71]
    ds_read_b64_tr_b16 v[172:173], v17 offset:14528
    v_mfma_f32_16x16x32_bf16 v[80:83], v[176:179], a[104:107], v[80:83]
    ds_read_b64_tr_b16 v[174:175], v17 offset:18112
    v_mfma_f32_16x16x32_bf16 v[84:87], v[176:179], a[108:111], v[84:87]
    ds_read_b64_tr_b16 v[176:177], v17 offset:14560
    v_mfma_f32_16x16x32_bf16 v[96:99], v[180:183], a[104:107], v[96:99]
    ds_read_b64_tr_b16 v[178:179], v17 offset:18144
    v_mfma_f32_16x16x32_bf16 v[100:103], v[180:183], a[108:111], v[100:103]
    ds_read_b64_tr_b16 v[180:181], v17 offset:14592
    v_mfma_f32_16x16x32_bf16 v[112:115], v[184:187], a[104:107], v[112:115]
    ds_read_b64_tr_b16 v[182:183], v17 offset:18176
    v_mfma_f32_16x16x32_bf16 v[116:119], v[184:187], a[108:111], v[116:119]
    ds_read_b64_tr_b16 v[184:185], v17 offset:14624
    v_mfma_f32_16x16x32_bf16 v[128:131], v[188:191], a[104:107], v[128:131]
    ds_read_b64_tr_b16 v[186:187], v17 offset:18208
    v_mfma_f32_16x16x32_bf16 v[132:135], v[188:191], a[108:111], v[132:135]
    ds_read_b64_tr_b16 v[188:189], v17 offset:14656
    ds_read_b64_tr_b16 v[190:191], v17 offset:18240
    s_waitcnt lgkmcnt(14)
    v_mfma_f32_16x16x32_bf16 v[24:27], v[136:139], a[112:115], v[24:27]
    buffer_load_dwordx4 a[16:19], v3, s[36:39], s15 offen offset:0 sc1
    v_mfma_f32_16x16x32_bf16 v[28:31], v[136:139], a[116:119], v[28:31]
    ds_read_b64_tr_b16 v[136:137], v17 offset:7168
    v_mfma_f32_16x16x32_bf16 v[40:43], v[140:143], a[112:115], v[40:43]
    ds_read_b64_tr_b16 v[138:139], v17 offset:10752
    buffer_load_dwordx4 a[20:23], v3, s[36:39], s15 offen offset:1024 sc1
    v_mfma_f32_16x16x32_bf16 v[44:47], v[140:143], a[116:119], v[44:47]
    ds_read_b64_tr_b16 v[140:141], v17 offset:7200
    v_mfma_f32_16x16x32_bf16 v[56:59], v[144:147], a[112:115], v[56:59]
    ds_read_b64_tr_b16 v[142:143], v17 offset:10784
    v_mfma_f32_16x16x32_bf16 v[60:63], v[144:147], a[116:119], v[60:63]
    ds_read_b64_tr_b16 v[144:145], v17 offset:7232
    v_mfma_f32_16x16x32_bf16 v[72:75], v[148:151], a[112:115], v[72:75]
    ds_read_b64_tr_b16 v[146:147], v17 offset:10816
    v_mfma_f32_16x16x32_bf16 v[76:79], v[148:151], a[116:119], v[76:79]
    ds_read_b64_tr_b16 v[148:149], v17 offset:7264
    v_mfma_f32_16x16x32_bf16 v[88:91], v[152:155], a[112:115], v[88:91]
    ds_read_b64_tr_b16 v[150:151], v17 offset:10848
    v_mfma_f32_16x16x32_bf16 v[92:95], v[152:155], a[116:119], v[92:95]
    ds_read_b64_tr_b16 v[152:153], v17 offset:7296
    v_mfma_f32_16x16x32_bf16 v[104:107], v[156:159], a[112:115], v[104:107]
    ds_read_b64_tr_b16 v[154:155], v17 offset:10880
    v_mfma_f32_16x16x32_bf16 v[108:111], v[156:159], a[116:119], v[108:111]
    ds_read_b64_tr_b16 v[156:157], v17 offset:7328
    v_mfma_f32_16x16x32_bf16 v[120:123], v[160:163], a[112:115], v[120:123]
    ds_read_b64_tr_b16 v[158:159], v17 offset:10912
    v_mfma_f32_16x16x32_bf16 v[124:127], v[160:163], a[116:119], v[124:127]
    ds_read_b64_tr_b16 v[160:161], v17 offset:7360
    ds_read_b64_tr_b16 v[162:163], v17 offset:10944
    s_waitcnt lgkmcnt(14)
    v_mfma_f32_16x16x32_bf16 v[32:35], v[164:167], a[112:115], v[32:35]
    buffer_load_dwordx4 a[24:27], v3, s[36:39], s15 offen offset:2048 sc1
    v_mfma_f32_16x16x32_bf16 v[36:39], v[164:167], a[116:119], v[36:39]
    ds_read_b64_tr_b16 v[164:165], v17 offset:21632
    v_mfma_f32_16x16x32_bf16 v[48:51], v[168:171], a[112:115], v[48:51]
    ds_read_b64_tr_b16 v[166:167], v17 offset:25216
    v_mfma_f32_16x16x32_bf16 v[52:55], v[168:171], a[116:119], v[52:55]
    ds_read_b64_tr_b16 v[168:169], v17 offset:21664
    v_mfma_f32_16x16x32_bf16 v[64:67], v[172:175], a[112:115], v[64:67]
    ds_read_b64_tr_b16 v[170:171], v17 offset:25248
    v_mfma_f32_16x16x32_bf16 v[68:71], v[172:175], a[116:119], v[68:71]
    ds_read_b64_tr_b16 v[172:173], v17 offset:21696
    v_mfma_f32_16x16x32_bf16 v[80:83], v[176:179], a[112:115], v[80:83]
    ds_read_b64_tr_b16 v[174:175], v17 offset:25280
    v_mfma_f32_16x16x32_bf16 v[84:87], v[176:179], a[116:119], v[84:87]
    ds_read_b64_tr_b16 v[176:177], v17 offset:21728
    v_mfma_f32_16x16x32_bf16 v[96:99], v[180:183], a[112:115], v[96:99]
    ds_read_b64_tr_b16 v[178:179], v17 offset:25312
    v_mfma_f32_16x16x32_bf16 v[100:103], v[180:183], a[116:119], v[100:103]
    ds_read_b64_tr_b16 v[180:181], v17 offset:21760
    v_mfma_f32_16x16x32_bf16 v[112:115], v[184:187], a[112:115], v[112:115]
    ds_read_b64_tr_b16 v[182:183], v17 offset:25344
    v_mfma_f32_16x16x32_bf16 v[116:119], v[184:187], a[116:119], v[116:119]
    ds_read_b64_tr_b16 v[184:185], v17 offset:21792
    v_mfma_f32_16x16x32_bf16 v[128:131], v[188:191], a[112:115], v[128:131]
    ds_read_b64_tr_b16 v[186:187], v17 offset:25376
    v_mfma_f32_16x16x32_bf16 v[132:135], v[188:191], a[116:119], v[132:135]
    ds_read_b64_tr_b16 v[188:189], v17 offset:21824
    ds_read_b64_tr_b16 v[190:191], v17 offset:25408
    s_waitcnt lgkmcnt(14)
    v_mfma_f32_16x16x32_bf16 v[24:27], v[136:139], a[120:123], v[24:27]
    buffer_load_dwordx4 a[28:31], v3, s[36:39], s15 offen offset:3072 sc1
    s_add_u32 s15, s15, 4096
    v_mfma_f32_16x16x32_bf16 v[28:31], v[136:139], a[124:127], v[28:31]
    v_mfma_f32_16x16x32_bf16 v[40:43], v[140:143], a[120:123], v[40:43]
    v_mfma_f32_16x16x32_bf16 v[44:47], v[140:143], a[124:127], v[44:47]
    v_mfma_f32_16x16x32_bf16 v[56:59], v[144:147], a[120:123], v[56:59]
    v_mfma_f32_16x16x32_bf16 v[60:63], v[144:147], a[124:127], v[60:63]
    v_mfma_f32_16x16x32_bf16 v[72:75], v[148:151], a[120:123], v[72:75]
    v_mfma_f32_16x16x32_bf16 v[76:79], v[148:151], a[124:127], v[76:79]
    v_mfma_f32_16x16x32_bf16 v[88:91], v[152:155], a[120:123], v[88:91]
    v_mfma_f32_16x16x32_bf16 v[92:95], v[152:155], a[124:127], v[92:95]
    v_mfma_f32_16x16x32_bf16 v[104:107], v[156:159], a[120:123], v[104:107]
    v_mfma_f32_16x16x32_bf16 v[108:111], v[156:159], a[124:127], v[108:111]
    v_mfma_f32_16x16x32_bf16 v[120:123], v[160:163], a[120:123], v[120:123]
    v_mfma_f32_16x16x32_bf16 v[124:127], v[160:163], a[124:127], v[124:127]
    s_waitcnt lgkmcnt(0)
    v_mfma_f32_16x16x32_bf16 v[32:35], v[164:167], a[120:123], v[32:35]
    v_mfma_f32_16x16x32_bf16 v[36:39], v[164:167], a[124:127], v[36:39]
    v_mfma_f32_16x16x32_bf16 v[48:51], v[168:171], a[120:123], v[48:51]
    v_mfma_f32_16x16x32_bf16 v[52:55], v[168:171], a[124:127], v[52:55]
    v_mfma_f32_16x16x32_bf16 v[64:67], v[172:175], a[120:123], v[64:67]
    v_mfma_f32_16x16x32_bf16 v[68:71], v[172:175], a[124:127], v[68:71]
    v_mfma_f32_16x16x32_bf16 v[80:83], v[176:179], a[120:123], v[80:83]
    v_mfma_f32_16x16x32_bf16 v[84:87], v[176:179], a[124:127], v[84:87]
    v_mfma_f32_16x16x32_bf16 v[96:99], v[180:183], a[120:123], v[96:99]
    v_mfma_f32_16x16x32_bf16 v[100:103], v[180:183], a[124:127], v[100:103]
    v_mfma_f32_16x16x32_bf16 v[112:115], v[184:187], a[120:123], v[112:115]
    v_mfma_f32_16x16x32_bf16 v[116:119], v[184:187], a[124:127], v[116:119]
    v_mfma_f32_16x16x32_bf16 v[128:131], v[188:191], a[120:123], v[128:131]
    v_mfma_f32_16x16x32_bf16 v[132:135], v[188:191], a[124:127], v[132:135]
    v_mul_f32 v24, v24, v32
    v_mul_f32 v25, v25, v33
    v_mul_f32 v26, v26, v34
    v_mul_f32 v27, v27, v35
    v_mul_f32 v28, v28, v36
    v_mul_f32 v29, v29, v37
    v_mul_f32 v30, v30, v38
    v_mul_f32 v31, v31, v39
    v_cvt_pk_bf16_f32 v136, v24, v25
    v_cvt_pk_bf16_f32 v137, v26, v27
    v_cvt_pk_bf16_f32 v138, v28, v29
    v_cvt_pk_bf16_f32 v139, v30, v31
    s_nop 0
    v_permlane16_swap_b32 v136, v138
    v_permlane16_swap_b32 v137, v139
    buffer_store_dwordx4 v[136:139], v3, s[36:39], s19 offen offset:0 sc1
    v_mul_f32 v40, v40, v48
    v_mul_f32 v41, v41, v49
    v_mul_f32 v42, v42, v50
    v_mul_f32 v43, v43, v51
    v_mul_f32 v44, v44, v52
    v_mul_f32 v45, v45, v53
    v_mul_f32 v46, v46, v54
    v_mul_f32 v47, v47, v55
    v_cvt_pk_bf16_f32 v140, v40, v41
    v_cvt_pk_bf16_f32 v141, v42, v43
    v_cvt_pk_bf16_f32 v142, v44, v45
    v_cvt_pk_bf16_f32 v143, v46, v47
    s_nop 0
    v_permlane16_swap_b32 v140, v142
    v_permlane16_swap_b32 v141, v143
    buffer_store_dwordx4 v[140:143], v3, s[36:39], s19 offen offset:1024 sc1
    v_mul_f32 v56, v56, v64
    v_mul_f32 v57, v57, v65
    v_mul_f32 v58, v58, v66
    v_mul_f32 v59, v59, v67
    v_mul_f32 v60, v60, v68
    v_mul_f32 v61, v61, v69
    v_mul_f32 v62, v62, v70
    v_mul_f32 v63, v63, v71
    v_cvt_pk_bf16_f32 v136, v56, v57
    v_cvt_pk_bf16_f32 v137, v58, v59
    v_cvt_pk_bf16_f32 v138, v60, v61
    v_cvt_pk_bf16_f32 v139, v62, v63
    s_nop 0
    v_permlane16_swap_b32 v136, v138
    v_permlane16_swap_b32 v137, v139
    buffer_store_dwordx4 v[136:139], v3, s[36:39], s19 offen offset:2048 sc1
    v_mul_f32 v72, v72, v80
    v_mul_f32 v73, v73, v81
    v_mul_f32 v74, v74, v82
    v_mul_f32 v75, v75, v83
    v_mul_f32 v76, v76, v84
    v_mul_f32 v77, v77, v85
    v_mul_f32 v78, v78, v86
    v_mul_f32 v79, v79, v87
    v_cvt_pk_bf16_f32 v140, v72, v73
    v_cvt_pk_bf16_f32 v141, v74, v75
    v_cvt_pk_bf16_f32 v142, v76, v77
    v_cvt_pk_bf16_f32 v143, v78, v79
    s_nop 0
    v_permlane16_swap_b32 v140, v142
    v_permlane16_swap_b32 v141, v143
    buffer_store_dwordx4 v[140:143], v3, s[36:39], s19 offen offset:3072 sc1
    v_mul_f32 v88, v88, v96
    v_mul_f32 v89, v89, v97
    v_mul_f32 v90, v90, v98
    v_mul_f32 v91, v91, v99
    v_mul_f32 v92, v92, v100
    v_mul_f32 v93, v93, v101
    v_mul_f32 v94, v94, v102
    v_mul_f32 v95, v95, v103
    v_cvt_pk_bf16_f32 v136, v88, v89
    v_cvt_pk_bf16_f32 v137, v90, v91
    v_cvt_pk_bf16_f32 v138, v92, v93
    v_cvt_pk_bf16_f32 v139, v94, v95
    s_nop 0
    v_permlane16_swap_b32 v136, v138
    v_permlane16_swap_b32 v137, v139
    s_add_u32 s19, s19, 4096
    buffer_store_dwordx4 v[136:139], v3, s[36:39], s19 offen offset:0 sc1
    v_mul_f32 v104, v104, v112
    v_mul_f32 v105, v105, v113
    v_mul_f32 v106, v106, v114
    v_mul_f32 v107, v107, v115
    v_mul_f32 v108, v108, v116
    v_mul_f32 v109, v109, v117
    v_mul_f32 v110, v110, v118
    v_mul_f32 v111, v111, v119
    v_cvt_pk_bf16_f32 v140, v104, v105
    v_cvt_pk_bf16_f32 v141, v106, v107
    v_cvt_pk_bf16_f32 v142, v108, v109
    v_cvt_pk_bf16_f32 v143, v110, v111
    s_nop 0
    v_permlane16_swap_b32 v140, v142
    v_permlane16_swap_b32 v141, v143
    buffer_store_dwordx4 v[140:143], v3, s[36:39], s19 offen offset:1024 sc1
    v_mul_f32 v120, v120, v128
    v_mul_f32 v121, v121, v129
    v_mul_f32 v122, v122, v130
    v_mul_f32 v123, v123, v131
    v_mul_f32 v124, v124, v132
    v_mul_f32 v125, v125, v133
    v_mul_f32 v126, v126, v134
    v_mul_f32 v127, v127, v135
    v_cvt_pk_bf16_f32 v136, v120, v121
    v_cvt_pk_bf16_f32 v137, v122, v123
    v_cvt_pk_bf16_f32 v138, v124, v125
    v_cvt_pk_bf16_f32 v139, v126, v127
    s_nop 0
    v_permlane16_swap_b32 v136, v138
    v_permlane16_swap_b32 v137, v139
    buffer_store_dwordx4 v[136:139], v3, s[36:39], s19 offen offset:2048 sc1
    s_add_u32 s4, s4, 32768
    v_lshrrev_b32 v13, 2, v0
    s_lshl_b32 s28, s13, 6
    v_add_u32 v14, s28, v13
    v_and_b32 v2, 3, v0
    v_lshlrev_b32 v10, 5, v2
    s_lshl_b32 s28, s14, 7
    v_add_u32 v10, s28, v10
    v_lshl_add_u32 v8, v14, 10, v10
    v_bfe_u32 v15, v14, 8, 2
    v_lshlrev_b32 v9, 9, v15
    v_bfe_u32 v15, v14, 6, 2
    v_lshl_add_u32 v9, v15, 7, v9
    v_and_b32 v15, 3, v14
    v_lshl_add_u32 v9, v15, 5, v9
    v_lshrrev_b32 v15, 10, v14
    v_lshl_add_u32 v9, v15, 4, v9
    v_bfe_u32 v15, v14, 2, 4
    v_add_u32 v9, v9, v15
    v_lshl_add_u32 v9, v9, 10, v10
    v_lshlrev_b32 v10, 1, v10
    v_add_u32 v10, 150784, v10
    v_mul_u32_u24 v11, 272, v13
    v_lshl_add_u32 v11, v2, 6, v11
    s_mul_i32 s28, s3, 17408
    v_and_b32 v2, 31, v1
    v_mul_u32_u24 v12, 272, v2
    v_lshrrev_b32 v2, 5, v1
    v_lshl_add_u32 v12, v2, 4, v12
    v_add_u32 v12, s28, v12
    s_lshr_b32 s5, s13, 1
    s_lshl_b32 s5, s5, 4
    s_lshl_b32 s28, s3, 2
    s_add_u32 s5, s5, s28
    s_lshl_b32 s5, s5, 7
    s_add_u32 s5, s5, 0x1308000
    s_waitcnt vmcnt(0)
    s_barrier
    s_cmp_lg_u32 s3, 0
    s_cbranch_scc1 adaLN_cond__spectral_gfnet__glu_gated_bilinear__prompt_kernel_PUB49
    s_mov_b64 exec, 1
    buffer_store_dword v6, v4, s[36:39], s4 offen sc1
    s_mov_b64 exec, -1
adaLN_cond__spectral_gfnet__glu_gated_bilinear__prompt_kernel_PUB49:
    s_mul_i32 s19, s13, 229376
    s_mul_i32 s28, s3, 28672
    s_add_u32 s19, s19, s28
    s_add_u32 s19, s19, 0xa40000
    s_add_u32 s20, s19, 114688
    s_mov_b32 s6, 0x640000
    s_mov_b32 s18, 0
    s_mov_b64 exec, 15
adaLN_cond__spectral_gfnet__glu_gated_bilinear__prompt_kernel_POLLB50:
    buffer_load_dword v7, v5, s[36:39], s5 offen sc1
    s_add_u32 s18, s18, 1
    s_waitcnt vmcnt(0)
    v_cmp_ne_u32 vcc, s34, v7
    s_nop 0
    s_cbranch_vccz adaLN_cond__spectral_gfnet__glu_gated_bilinear__prompt_kernel_POLLBD51
    s_cmp_lt_u32 s18, 0x20000
    s_cbranch_scc1 adaLN_cond__spectral_gfnet__glu_gated_bilinear__prompt_kernel_POLLB50
adaLN_cond__spectral_gfnet__glu_gated_bilinear__prompt_kernel_POLLBD51:
    s_mov_b64 exec, -1
    buffer_load_dwordx4 a[32:35], v3, s[36:39], s19 offen offset:0 sc1
    buffer_load_dwordx4 a[36:39], v3, s[36:39], s20 offen offset:0 sc1
    buffer_load_dwordx4 a[40:43], v3, s[36:39], s19 offen offset:1024 sc1
    buffer_load_dwordx4 a[44:47], v3, s[36:39], s20 offen offset:1024 sc1
    buffer_load_dwordx4 a[48:51], v3, s[36:39], s19 offen offset:2048 sc1
    buffer_load_dwordx4 a[52:55], v3, s[36:39], s20 offen offset:2048 sc1
    buffer_load_dwordx4 a[56:59], v3, s[36:39], s19 offen offset:3072 sc1
    buffer_load_dwordx4 a[60:63], v3, s[36:39], s20 offen offset:3072 sc1
    s_add_u32 s19, s19, 4096
    s_add_u32 s20, s20, 4096
    buffer_load_dwordx4 a[64:67], v3, s[36:39], s19 offen offset:0 sc1
    buffer_load_dwordx4 a[68:71], v3, s[36:39], s20 offen offset:0 sc1
    buffer_load_dwordx4 a[72:75], v3, s[36:39], s19 offen offset:1024 sc1
    buffer_load_dwordx4 a[76:79], v3, s[36:39], s20 offen offset:1024 sc1
    buffer_load_dwordx4 a[80:83], v3, s[36:39], s19 offen offset:2048 sc1
    buffer_load_dwordx4 a[84:87], v3, s[36:39], s20 offen offset:2048 sc1
    buffer_load_dwordx4 a[88:91], v3, s[36:39], s19 offen offset:3072 sc1
    buffer_load_dwordx4 a[92:95], v3, s[36:39], s20 offen offset:3072 sc1
    s_add_u32 s19, s19, 4096
    s_add_u32 s20, s20, 4096
    buffer_load_dwordx4 a[96:99], v3, s[36:39], s19 offen offset:0 sc1
    buffer_load_dwordx4 a[100:103], v3, s[36:39], s20 offen offset:0 sc1
    buffer_load_dwordx4 a[104:107], v3, s[36:39], s19 offen offset:1024 sc1
    buffer_load_dwordx4 a[108:111], v3, s[36:39], s20 offen offset:1024 sc1
    s_waitcnt vmcnt(18)
    v_mfma_f32_32x32x16_bf16 v[24:39], a[128:131], a[32:35], 0
    buffer_load_dwordx4 a[112:115], v3, s[36:39], s19 offen offset:2048 sc1
    v_mfma_f32_32x32x16_bf16 v[40:55], a[128:131], a[36:39], 0
    v_mfma_f32_32x32x16_bf16 v[56:71], a[132:135], a[32:35], 0
    buffer_load_dwordx4 a[116:119], v3, s[36:39], s20 offen offset:2048 sc1
    v_mfma_f32_32x32x16_bf16 v[72:87], a[132:135], a[36:39], 0
    s_waitcnt vmcnt(18)
    v_mfma_f32_32x32x16_bf16 v[24:39], a[136:139], a[40:43], v[24:39]
    buffer_load_dwordx4 a[120:123], v3, s[36:39], s19 offen offset:3072 sc1
    v_mfma_f32_32x32x16_bf16 v[40:55], a[136:139], a[44:47], v[40:55]
    v_mfma_f32_32x32x16_bf16 v[56:71], a[140:143], a[40:43], v[56:71]
    buffer_load_dwordx4 a[124:127], v3, s[36:39], s20 offen offset:3072 sc1
    s_add_u32 s19, s19, 4096
    s_add_u32 s20, s20, 4096
    v_mfma_f32_32x32x16_bf16 v[72:87], a[140:143], a[44:47], v[72:87]
    s_waitcnt vmcnt(18)
    v_mfma_f32_32x32x16_bf16 v[24:39], a[144:147], a[48:51], v[24:39]
    buffer_load_dwordx4 v[88:91], v3, s[36:39], s19 offen offset:0 sc1
    v_mfma_f32_32x32x16_bf16 v[40:55], a[144:147], a[52:55], v[40:55]
    v_mfma_f32_32x32x16_bf16 v[56:71], a[148:151], a[48:51], v[56:71]
    buffer_load_dwordx4 v[92:95], v3, s[36:39], s20 offen offset:0 sc1
    v_mfma_f32_32x32x16_bf16 v[72:87], a[148:151], a[52:55], v[72:87]
    s_waitcnt vmcnt(18)
    v_mfma_f32_32x32x16_bf16 v[24:39], a[152:155], a[56:59], v[24:39]
    buffer_load_dwordx4 v[96:99], v3, s[36:39], s19 offen offset:1024 sc1
    v_mfma_f32_32x32x16_bf16 v[40:55], a[152:155], a[60:63], v[40:55]
    v_mfma_f32_32x32x16_bf16 v[56:71], a[156:159], a[56:59], v[56:71]
    buffer_load_dwordx4 v[100:103], v3, s[36:39], s20 offen offset:1024 sc1
    v_mfma_f32_32x32x16_bf16 v[72:87], a[156:159], a[60:63], v[72:87]
    s_waitcnt vmcnt(18)
    v_mfma_f32_32x32x16_bf16 v[24:39], a[160:163], a[64:67], v[24:39]
    buffer_load_dwordx4 v[104:107], v3, s[36:39], s19 offen offset:2048 sc1
    v_mfma_f32_32x32x16_bf16 v[40:55], a[160:163], a[68:71], v[40:55]
    v_mfma_f32_32x32x16_bf16 v[56:71], a[164:167], a[64:67], v[56:71]
    buffer_load_dwordx4 v[108:111], v3, s[36:39], s20 offen offset:2048 sc1
    v_mfma_f32_32x32x16_bf16 v[72:87], a[164:167], a[68:71], v[72:87]
    s_waitcnt vmcnt(18)
    v_mfma_f32_32x32x16_bf16 v[24:39], a[168:171], a[72:75], v[24:39]
    buffer_load_dwordx4 v[112:115], v3, s[36:39], s19 offen offset:3072 sc1
    v_mfma_f32_32x32x16_bf16 v[40:55], a[168:171], a[76:79], v[40:55]
    v_mfma_f32_32x32x16_bf16 v[56:71], a[172:175], a[72:75], v[56:71]
    buffer_load_dwordx4 v[116:119], v3, s[36:39], s20 offen offset:3072 sc1
    s_add_u32 s19, s19, 4096
    s_add_u32 s20, s20, 4096
    v_mfma_f32_32x32x16_bf16 v[72:87], a[172:175], a[76:79], v[72:87]
    s_waitcnt vmcnt(18)
    v_mfma_f32_32x32x16_bf16 v[24:39], a[176:179], a[80:83], v[24:39]
    buffer_load_dwordx4 v[120:123], v3, s[36:39], s19 offen offset:0 sc1
    v_mfma_f32_32x32x16_bf16 v[40:55], a[176:179], a[84:87], v[40:55]
    v_mfma_f32_32x32x16_bf16 v[56:71], a[180:183], a[80:83], v[56:71]
    buffer_load_dwordx4 v[124:127], v3, s[36:39], s20 offen offset:0 sc1
    v_mfma_f32_32x32x16_bf16 v[72:87], a[180:183], a[84:87], v[72:87]
    s_waitcnt vmcnt(18)
    v_mfma_f32_32x32x16_bf16 v[24:39], a[184:187], a[88:91], v[24:39]
    buffer_load_dwordx4 v[128:131], v3, s[36:39], s19 offen offset:1024 sc1
    v_mfma_f32_32x32x16_bf16 v[40:55], a[184:187], a[92:95], v[40:55]
    v_mfma_f32_32x32x16_bf16 v[56:71], a[188:191], a[88:91], v[56:71]
    buffer_load_dwordx4 v[132:135], v3, s[36:39], s20 offen offset:1024 sc1
    v_mfma_f32_32x32x16_bf16 v[72:87], a[188:191], a[92:95], v[72:87]
    s_waitcnt vmcnt(18)
    v_mfma_f32_32x32x16_bf16 v[24:39], a[192:195], a[96:99], v[24:39]
    buffer_load_dwordx4 v[136:139], v3, s[36:39], s19 offen offset:2048 sc1
    v_mfma_f32_32x32x16_bf16 v[40:55], a[192:195], a[100:103], v[40:55]
    v_mfma_f32_32x32x16_bf16 v[56:71], a[196:199], a[96:99], v[56:71]
    buffer_load_dwordx4 v[140:143], v3, s[36:39], s20 offen offset:2048 sc1
    v_mfma_f32_32x32x16_bf16 v[72:87], a[196:199], a[100:103], v[72:87]
    s_waitcnt vmcnt(18)
    v_mfma_f32_32x32x16_bf16 v[24:39], a[200:203], a[104:107], v[24:39]
    buffer_load_dwordx4 v[144:147], v3, s[36:39], s19 offen offset:3072 sc1
    v_mfma_f32_32x32x16_bf16 v[40:55], a[200:203], a[108:111], v[40:55]
    v_mfma_f32_32x32x16_bf16 v[56:71], a[204:207], a[104:107], v[56:71]
    buffer_load_dwordx4 v[148:151], v3, s[36:39], s20 offen offset:3072 sc1
    s_add_u32 s19, s19, 4096
    s_add_u32 s20, s20, 4096
    v_mfma_f32_32x32x16_bf16 v[72:87], a[204:207], a[108:111], v[72:87]
    s_waitcnt vmcnt(18)
    v_mfma_f32_32x32x16_bf16 v[24:39], a[208:211], a[112:115], v[24:39]
    buffer_load_dwordx4 v[152:155], v3, s[36:39], s19 offen offset:0 sc1
    v_mfma_f32_32x32x16_bf16 v[40:55], a[208:211], a[116:119], v[40:55]
    v_mfma_f32_32x32x16_bf16 v[56:71], a[212:215], a[112:115], v[56:71]
    buffer_load_dwordx4 v[156:159], v3, s[36:39], s20 offen offset:0 sc1
    v_mfma_f32_32x32x16_bf16 v[72:87], a[212:215], a[116:119], v[72:87]
    s_waitcnt vmcnt(18)
    v_mfma_f32_32x32x16_bf16 v[24:39], a[216:219], a[120:123], v[24:39]
    buffer_load_dwordx4 v[160:163], v3, s[36:39], s19 offen offset:1024 sc1
    v_mfma_f32_32x32x16_bf16 v[40:55], a[216:219], a[124:127], v[40:55]
    v_mfma_f32_32x32x16_bf16 v[56:71], a[220:223], a[120:123], v[56:71]
    buffer_load_dwordx4 v[164:167], v3, s[36:39], s20 offen offset:1024 sc1
    v_mfma_f32_32x32x16_bf16 v[72:87], a[220:223], a[124:127], v[72:87]
    s_waitcnt vmcnt(18)
    v_mfma_f32_32x32x16_bf16 v[24:39], a[224:227], v[88:91], v[24:39]
    buffer_load_dwordx4 v[168:171], v3, s[36:39], s19 offen offset:2048 sc1
    v_mfma_f32_32x32x16_bf16 v[40:55], a[224:227], v[92:95], v[40:55]
    v_mfma_f32_32x32x16_bf16 v[56:71], a[228:231], v[88:91], v[56:71]
    buffer_load_dwordx4 v[172:175], v3, s[36:39], s20 offen offset:2048 sc1
    v_mfma_f32_32x32x16_bf16 v[72:87], a[228:231], v[92:95], v[72:87]
    s_waitcnt vmcnt(18)
    v_mfma_f32_32x32x16_bf16 v[24:39], a[232:235], v[96:99], v[24:39]
    buffer_load_dwordx4 v[176:179], v3, s[36:39], s19 offen offset:3072 sc1
    v_mfma_f32_32x32x16_bf16 v[40:55], a[232:235], v[100:103], v[40:55]
    v_mfma_f32_32x32x16_bf16 v[56:71], a[236:239], v[96:99], v[56:71]
    buffer_load_dwordx4 v[180:183], v3, s[36:39], s20 offen offset:3072 sc1
    s_add_u32 s19, s19, 4096
    s_add_u32 s20, s20, 4096
    v_mfma_f32_32x32x16_bf16 v[72:87], a[236:239], v[100:103], v[72:87]
    s_waitcnt vmcnt(18)
    v_mfma_f32_32x32x16_bf16 v[24:39], a[240:243], v[104:107], v[24:39]
    buffer_load_dwordx4 a[32:35], v3, s[36:39], s19 offen offset:0 sc1
    v_mfma_f32_32x32x16_bf16 v[40:55], a[240:243], v[108:111], v[40:55]
    v_mfma_f32_32x32x16_bf16 v[56:71], a[244:247], v[104:107], v[56:71]
    buffer_load_dwordx4 a[36:39], v3, s[36:39], s20 offen offset:0 sc1
    v_mfma_f32_32x32x16_bf16 v[72:87], a[244:247], v[108:111], v[72:87]
    s_waitcnt vmcnt(18)
    v_mfma_f32_32x32x16_bf16 v[24:39], a[248:251], v[112:115], v[24:39]
    buffer_load_dwordx4 a[40:43], v3, s[36:39], s19 offen offset:1024 sc1
    v_mfma_f32_32x32x16_bf16 v[40:55], a[248:251], v[116:119], v[40:55]
    v_mfma_f32_32x32x16_bf16 v[56:71], a[252:255], v[112:115], v[56:71]
    buffer_load_dwordx4 a[44:47], v3, s[36:39], s20 offen offset:1024 sc1
    v_mfma_f32_32x32x16_bf16 v[72:87], a[252:255], v[116:119], v[72:87]
    s_waitcnt vmcnt(18)
    v_mfma_f32_32x32x16_bf16 v[24:39], v[192:195], v[120:123], v[24:39]
    buffer_load_dwordx4 a[48:51], v3, s[36:39], s19 offen offset:2048 sc1
    v_mfma_f32_32x32x16_bf16 v[40:55], v[192:195], v[124:127], v[40:55]
    v_mfma_f32_32x32x16_bf16 v[56:71], v[196:199], v[120:123], v[56:71]
    buffer_load_dwordx4 a[52:55], v3, s[36:39], s20 offen offset:2048 sc1
    v_mfma_f32_32x32x16_bf16 v[72:87], v[196:199], v[124:127], v[72:87]
    s_waitcnt vmcnt(18)
    v_mfma_f32_32x32x16_bf16 v[24:39], v[200:203], v[128:131], v[24:39]
    buffer_load_dwordx4 a[56:59], v3, s[36:39], s19 offen offset:3072 sc1
    v_mfma_f32_32x32x16_bf16 v[40:55], v[200:203], v[132:135], v[40:55]
    v_mfma_f32_32x32x16_bf16 v[56:71], v[204:207], v[128:131], v[56:71]
    buffer_load_dwordx4 a[60:63], v3, s[36:39], s20 offen offset:3072 sc1
    s_add_u32 s19, s19, 4096
    s_add_u32 s20, s20, 4096
    v_mfma_f32_32x32x16_bf16 v[72:87], v[204:207], v[132:135], v[72:87]
    s_waitcnt vmcnt(18)
    v_mfma_f32_32x32x16_bf16 v[24:39], v[208:211], v[136:139], v[24:39]
    buffer_load_dwordx4 v[184:187], v8, s[36:39], s6 offen sc1
    v_mfma_f32_32x32x16_bf16 v[40:55], v[208:211], v[140:143], v[40:55]
    v_mfma_f32_32x32x16_bf16 v[56:71], v[212:215], v[136:139], v[56:71]
    buffer_load_dwordx4 v[188:191], v8, s[36:39], s6 offen offset:16 sc1
    v_mfma_f32_32x32x16_bf16 v[72:87], v[212:215], v[140:143], v[72:87]
    s_waitcnt vmcnt(18)
    v_mfma_f32_32x32x16_bf16 v[24:39], v[216:219], v[144:147], v[24:39]
    v_mfma_f32_32x32x16_bf16 v[40:55], v[216:219], v[148:151], v[40:55]
    v_mfma_f32_32x32x16_bf16 v[56:71], v[220:223], v[144:147], v[56:71]
    v_mfma_f32_32x32x16_bf16 v[72:87], v[220:223], v[148:151], v[72:87]
    s_waitcnt vmcnt(16)
    v_mfma_f32_32x32x16_bf16 v[24:39], v[224:227], v[152:155], v[24:39]
    v_mfma_f32_32x32x16_bf16 v[40:55], v[224:227], v[156:159], v[40:55]
    v_mfma_f32_32x32x16_bf16 v[56:71], v[228:231], v[152:155], v[56:71]
    v_mfma_f32_32x32x16_bf16 v[72:87], v[228:231], v[156:159], v[72:87]
    s_waitcnt vmcnt(14)
    v_mfma_f32_32x32x16_bf16 v[24:39], v[232:235], v[160:163], v[24:39]
    v_mfma_f32_32x32x16_bf16 v[40:55], v[232:235], v[164:167], v[40:55]
    v_mfma_f32_32x32x16_bf16 v[56:71], v[236:239], v[160:163], v[56:71]
    v_mfma_f32_32x32x16_bf16 v[72:87], v[236:239], v[164:167], v[72:87]
    s_waitcnt vmcnt(12)
    v_mfma_f32_32x32x16_bf16 v[24:39], v[240:243], v[168:171], v[24:39]
    v_mfma_f32_32x32x16_bf16 v[40:55], v[240:243], v[172:175], v[40:55]
    v_mfma_f32_32x32x16_bf16 v[56:71], v[244:247], v[168:171], v[56:71]
    v_mfma_f32_32x32x16_bf16 v[72:87], v[244:247], v[172:175], v[72:87]
    s_waitcnt vmcnt(10)
    v_mfma_f32_32x32x16_bf16 v[24:39], v[248:251], v[176:179], v[24:39]
    v_mfma_f32_32x32x16_bf16 v[40:55], v[248:251], v[180:183], v[40:55]
    v_mfma_f32_32x32x16_bf16 v[56:71], v[252:255], v[176:179], v[56:71]
    v_mfma_f32_32x32x16_bf16 v[72:87], v[252:255], v[180:183], v[72:87]
    s_waitcnt vmcnt(8)
    v_mfma_f32_32x32x16_bf16 v[24:39], a[0:3], a[32:35], v[24:39]
    v_mfma_f32_32x32x16_bf16 v[40:55], a[0:3], a[36:39], v[40:55]
    v_mfma_f32_32x32x16_bf16 v[56:71], a[4:7], a[32:35], v[56:71]
    v_mfma_f32_32x32x16_bf16 v[72:87], a[4:7], a[36:39], v[72:87]
    s_waitcnt vmcnt(6)
    v_mfma_f32_32x32x16_bf16 v[24:39], a[8:11], a[40:43], v[24:39]
    v_mfma_f32_32x32x16_bf16 v[40:55], a[8:11], a[44:47], v[40:55]
    v_mfma_f32_32x32x16_bf16 v[56:71], a[12:15], a[40:43], v[56:71]
    v_mfma_f32_32x32x16_bf16 v[72:87], a[12:15], a[44:47], v[72:87]
    s_waitcnt vmcnt(4)
    v_mfma_f32_32x32x16_bf16 v[24:39], a[16:19], a[48:51], v[24:39]
    v_mfma_f32_32x32x16_bf16 v[40:55], a[16:19], a[52:55], v[40:55]
    v_mfma_f32_32x32x16_bf16 v[56:71], a[20:23], a[48:51], v[56:71]
    v_mfma_f32_32x32x16_bf16 v[72:87], a[20:23], a[52:55], v[72:87]
    s_waitcnt vmcnt(2)
    v_mfma_f32_32x32x16_bf16 v[24:39], a[24:27], a[56:59], v[24:39]
    v_mfma_f32_32x32x16_bf16 v[40:55], a[24:27], a[60:63], v[40:55]
    v_mfma_f32_32x32x16_bf16 v[56:71], a[28:31], a[56:59], v[56:71]
    v_mfma_f32_32x32x16_bf16 v[72:87], a[28:31], a[60:63], v[72:87]
    s_nop 8
    ds_write_b128 v12, v[24:27] offset:0
    ds_write_b128 v12, v[28:31] offset:32
    ds_write_b128 v12, v[32:35] offset:64
    ds_write_b128 v12, v[36:39] offset:96
    ds_write_b128 v12, v[56:59] offset:128
    ds_write_b128 v12, v[60:63] offset:160
    ds_write_b128 v12, v[64:67] offset:192
    ds_write_b128 v12, v[68:71] offset:224
    ds_write_b128 v12, v[40:43] offset:8704
    ds_write_b128 v12, v[44:47] offset:8736
    ds_write_b128 v12, v[48:51] offset:8768
    ds_write_b128 v12, v[52:55] offset:8800
    ds_write_b128 v12, v[72:75] offset:8832
    ds_write_b128 v12, v[76:79] offset:8864
    ds_write_b128 v12, v[80:83] offset:8896
    ds_write_b128 v12, v[84:87] offset:8928
    s_mov_b32 s40, s22
    s_mov_b32 s41, s23
    s_mov_b32 s42, 0x200000
    s_mov_b32 s43, 0x00020000
    ds_read_b128 v[192:195], v10 offset:0
    ds_read_b128 v[196:199], v10 offset:16
    ds_read_b128 v[200:203], v10 offset:32
    ds_read_b128 v[204:207], v10 offset:48
    s_waitcnt lgkmcnt(0)
    s_barrier
    ds_read_b128 v[24:27], v11 offset:0
    ds_read_b128 v[28:31], v11 offset:16
    ds_read_b128 v[32:35], v11 offset:32
    ds_read_b128 v[36:39], v11 offset:48
    ds_read_b128 v[40:43], v11 offset:17408
    ds_read_b128 v[44:47], v11 offset:17424
    ds_read_b128 v[48:51], v11 offset:17440
    ds_read_b128 v[52:55], v11 offset:17456
    ds_read_b128 v[56:59], v11 offset:34816
    ds_read_b128 v[60:63], v11 offset:34832
    ds_read_b128 v[64:67], v11 offset:34848
    ds_read_b128 v[68:71], v11 offset:34864
    ds_read_b128 v[72:75], v11 offset:52224
    ds_read_b128 v[76:79], v11 offset:52240
    ds_read_b128 v[80:83], v11 offset:52256
    ds_read_b128 v[84:87], v11 offset:52272
    s_waitcnt lgkmcnt(8)
    v_add_f32 v24, v24, v40
    v_add_f32 v25, v25, v41
    v_add_f32 v26, v26, v42
    v_add_f32 v27, v27, v43
    v_add_f32 v28, v28, v44
    v_add_f32 v29, v29, v45
    v_add_f32 v30, v30, v46
    v_add_f32 v31, v31, v47
    v_add_f32 v32, v32, v48
    v_add_f32 v33, v33, v49
    v_add_f32 v34, v34, v50
    v_add_f32 v35, v35, v51
    v_add_f32 v36, v36, v52
    v_add_f32 v37, v37, v53
    v_add_f32 v38, v38, v54
    v_add_f32 v39, v39, v55
    s_waitcnt lgkmcnt(0)
    v_add_f32 v56, v56, v72
    v_add_f32 v57, v57, v73
    v_add_f32 v58, v58, v74
    v_add_f32 v59, v59, v75
    v_add_f32 v60, v60, v76
    v_add_f32 v61, v61, v77
    v_add_f32 v62, v62, v78
    v_add_f32 v63, v63, v79
    v_add_f32 v64, v64, v80
    v_add_f32 v65, v65, v81
    v_add_f32 v66, v66, v82
    v_add_f32 v67, v67, v83
    v_add_f32 v68, v68, v84
    v_add_f32 v69, v69, v85
    v_add_f32 v70, v70, v86
    v_add_f32 v71, v71, v87
    v_add_f32 v24, v24, v56
    v_add_f32 v25, v25, v57
    v_add_f32 v26, v26, v58
    v_add_f32 v27, v27, v59
    v_add_f32 v28, v28, v60
    v_add_f32 v29, v29, v61
    v_add_f32 v30, v30, v62
    v_add_f32 v31, v31, v63
    v_add_f32 v32, v32, v64
    v_add_f32 v33, v33, v65
    v_add_f32 v34, v34, v66
    v_add_f32 v35, v35, v67
    v_add_f32 v36, v36, v68
    v_add_f32 v37, v37, v69
    v_add_f32 v38, v38, v70
    v_add_f32 v39, v39, v71
    s_waitcnt vmcnt(0)
    v_lshlrev_b32 v40, 16, v184
    v_and_b32 v41, 0xffff0000, v184
    v_lshlrev_b32 v42, 16, v185
    v_and_b32 v43, 0xffff0000, v185
    v_lshlrev_b32 v44, 16, v186
    v_and_b32 v45, 0xffff0000, v186
    v_lshlrev_b32 v46, 16, v187
    v_and_b32 v47, 0xffff0000, v187
    v_lshlrev_b32 v48, 16, v188
    v_and_b32 v49, 0xffff0000, v188
    v_lshlrev_b32 v50, 16, v189
    v_and_b32 v51, 0xffff0000, v189
    v_lshlrev_b32 v52, 16, v190
    v_and_b32 v53, 0xffff0000, v190
    v_lshlrev_b32 v54, 16, v191
    v_and_b32 v55, 0xffff0000, v191
    v_fmac_f32 v40, v192, v24
    v_fmac_f32 v41, v193, v25
    v_fmac_f32 v42, v194, v26
    v_fmac_f32 v43, v195, v27
    v_fmac_f32 v44, v196, v28
    v_fmac_f32 v45, v197, v29
    v_fmac_f32 v46, v198, v30
    v_fmac_f32 v47, v199, v31
    v_fmac_f32 v48, v200, v32
    v_fmac_f32 v49, v201, v33
    v_fmac_f32 v50, v202, v34
    v_fmac_f32 v51, v203, v35
    v_fmac_f32 v52, v204, v36
    v_fmac_f32 v53, v205, v37
    v_fmac_f32 v54, v206, v38
    v_fmac_f32 v55, v207, v39
    v_cvt_pk_bf16_f32 v184, v40, v41
    v_cvt_pk_bf16_f32 v185, v42, v43
    v_cvt_pk_bf16_f32 v186, v44, v45
    v_cvt_pk_bf16_f32 v187, v46, v47
    v_cvt_pk_bf16_f32 v188, v48, v49
    v_cvt_pk_bf16_f32 v189, v50, v51
    v_cvt_pk_bf16_f32 v190, v52, v53
    v_cvt_pk_bf16_f32 v191, v54, v55
    buffer_store_dwordx4 v[184:187], v9, s[40:43], 0 offen
    buffer_store_dwordx4 v[188:191], v9, s[40:43], 0 offen offset:16
    s_endpgm
adaLN_cond__spectral_gfnet__glu_gated_bilinear__prompt_kernel_PQ35:
    s_lshl_b32 s28, s3, 4
    v_add_u32 v2, s28, v24
    v_lshl_add_u32 v2, v25, 8, v2
    v_lshlrev_b32 v2, 2, v2
    v_add_u32 v26, 115712, v2
    v_sub_u32 v63, 119040, v2
    s_waitcnt vmcnt(1)
    ds_write2st64_b32 v26, v112, v113 offset0:0 offset1:1
    ds_write2st64_b32 v26, v114, v115 offset0:2 offset1:3
    ds_write2st64_b32 v26, v116, v117 offset0:16 offset1:17
    ds_write2st64_b32 v26, v118, v119 offset0:18 offset1:19
    ds_write2st64_b32 v26, v120, v121 offset0:33 offset1:34
    ds_write2st64_b32 v26, v122, v123 offset0:35 offset1:36
    ds_write2st64_b32 v26, v124, v125 offset0:49 offset1:50
    ds_write2st64_b32 v26, v126, v127 offset0:51 offset1:52
    s_cmp_lg_u32 s3, 0
    s_cbranch_scc1 adaLN_cond__spectral_gfnet__glu_gated_bilinear__prompt_kernel_RX39
    s_mov_b64 exec, 1
    ds_write_b32 v26, v112 offset:8192
    ds_write_b32 v26, v120 offset:16640
    s_mov_b64 exec, -1
adaLN_cond__spectral_gfnet__glu_gated_bilinear__prompt_kernel_RX39:
    s_waitcnt lgkmcnt(0)
    s_barrier
    ds_read2st64_b32 v[28:29], v63 offset0:19 offset1:18
    ds_read2st64_b32 v[30:31], v63 offset0:17 offset1:16
    ds_read2st64_b32 v[32:33], v63 offset0:3 offset1:2
    ds_read2st64_b32 v[34:35], v63 offset0:1 offset1:0
    ds_read2st64_b32 v[176:177], v63 offset0:52 offset1:51
    ds_read2st64_b32 v[178:179], v63 offset0:50 offset1:49
    ds_read2st64_b32 v[180:181], v63 offset0:36 offset1:35
    ds_read2st64_b32 v[182:183], v63 offset0:34 offset1:33
    s_waitcnt lgkmcnt(0)
    s_barrier
    v_lshlrev_b32 v57, 16, v112
    v_lshlrev_b32 v58, 16, v28
    v_and_b32 v59, 0xffff0000, v112
    v_and_b32 v60, 0xffff0000, v28
    v_add_f32 v224, v57, v58
    v_sub_f32 v228, v59, v60
    v_lshlrev_b32 v57, 16, v120
    v_lshlrev_b32 v58, 16, v176
    v_and_b32 v59, 0xffff0000, v120
    v_and_b32 v60, 0xffff0000, v176
    v_add_f32 v57, v57, v58
    v_sub_f32 v59, v59, v60
    v_sub_f32 v232, v224, v57
    v_sub_f32 v236, v228, v59
    v_add_f32 v224, v224, v57
    v_add_f32 v228, v228, v59
    v_lshlrev_b32 v57, 16, v113
    v_lshlrev_b32 v58, 16, v29
    v_and_b32 v59, 0xffff0000, v113
    v_and_b32 v60, 0xffff0000, v29
    v_add_f32 v225, v57, v58
    v_sub_f32 v229, v59, v60
    v_lshlrev_b32 v57, 16, v121
    v_lshlrev_b32 v58, 16, v177
    v_and_b32 v59, 0xffff0000, v121
    v_and_b32 v60, 0xffff0000, v177
    v_add_f32 v57, v57, v58
    v_sub_f32 v59, v59, v60
    v_sub_f32 v233, v225, v57
    v_sub_f32 v237, v229, v59
    v_add_f32 v225, v225, v57
    v_add_f32 v229, v229, v59
    v_lshlrev_b32 v57, 16, v114
    v_lshlrev_b32 v58, 16, v30
    v_and_b32 v59, 0xffff0000, v114
    v_and_b32 v60, 0xffff0000, v30
    v_add_f32 v226, v57, v58
    v_sub_f32 v230, v59, v60
    v_lshlrev_b32 v57, 16, v122
    v_lshlrev_b32 v58, 16, v178
    v_and_b32 v59, 0xffff0000, v122
    v_and_b32 v60, 0xffff0000, v178
    v_add_f32 v57, v57, v58
    v_sub_f32 v59, v59, v60
    v_sub_f32 v234, v226, v57
    v_sub_f32 v238, v230, v59
    v_add_f32 v226, v226, v57
    v_add_f32 v230, v230, v59
    v_lshlrev_b32 v57, 16, v115
    v_lshlrev_b32 v58, 16, v31
    v_and_b32 v59, 0xffff0000, v115
    v_and_b32 v60, 0xffff0000, v31
    v_add_f32 v227, v57, v58
    v_sub_f32 v231, v59, v60
    v_lshlrev_b32 v57, 16, v123
    v_lshlrev_b32 v58, 16, v179
    v_and_b32 v59, 0xffff0000, v123
    v_and_b32 v60, 0xffff0000, v179
    v_add_f32 v57, v57, v58
    v_sub_f32 v59, v59, v60
    v_sub_f32 v235, v227, v57
    v_sub_f32 v239, v231, v59
    v_add_f32 v227, v227, v57
    v_add_f32 v231, v231, v59
    v_lshlrev_b32 v57, 16, v116
    v_lshlrev_b32 v58, 16, v32
    v_and_b32 v59, 0xffff0000, v116
    v_and_b32 v60, 0xffff0000, v32
    v_add_f32 v240, v57, v58
    v_sub_f32 v244, v59, v60
    v_lshlrev_b32 v57, 16, v124
    v_lshlrev_b32 v58, 16, v180
    v_and_b32 v59, 0xffff0000, v124
    v_and_b32 v60, 0xffff0000, v180
    v_add_f32 v57, v57, v58
    v_sub_f32 v59, v59, v60
    v_sub_f32 v248, v240, v57
    v_sub_f32 v252, v244, v59
    v_add_f32 v240, v240, v57
    v_add_f32 v244, v244, v59
    v_lshlrev_b32 v57, 16, v117
    v_lshlrev_b32 v58, 16, v33
    v_and_b32 v59, 0xffff0000, v117
    v_and_b32 v60, 0xffff0000, v33
    v_add_f32 v241, v57, v58
    v_sub_f32 v245, v59, v60
    v_lshlrev_b32 v57, 16, v125
    v_lshlrev_b32 v58, 16, v181
    v_and_b32 v59, 0xffff0000, v125
    v_and_b32 v60, 0xffff0000, v181
    v_add_f32 v57, v57, v58
    v_sub_f32 v59, v59, v60
    v_sub_f32 v249, v241, v57
    v_sub_f32 v253, v245, v59
    v_add_f32 v241, v241, v57
    v_add_f32 v245, v245, v59
    v_lshlrev_b32 v57, 16, v118
    v_lshlrev_b32 v58, 16, v34
    v_and_b32 v59, 0xffff0000, v118
    v_and_b32 v60, 0xffff0000, v34
    v_add_f32 v242, v57, v58
    v_sub_f32 v246, v59, v60
    v_lshlrev_b32 v57, 16, v126
    v_lshlrev_b32 v58, 16, v182
    v_and_b32 v59, 0xffff0000, v126
    v_and_b32 v60, 0xffff0000, v182
    v_add_f32 v57, v57, v58
    v_sub_f32 v59, v59, v60
    v_sub_f32 v250, v242, v57
    v_sub_f32 v254, v246, v59
    v_add_f32 v242, v242, v57
    v_add_f32 v246, v246, v59
    v_lshlrev_b32 v57, 16, v119
    v_lshlrev_b32 v58, 16, v35
    v_and_b32 v59, 0xffff0000, v119
    v_and_b32 v60, 0xffff0000, v35
    v_add_f32 v243, v57, v58
    v_sub_f32 v247, v59, v60
    v_lshlrev_b32 v57, 16, v127
    v_lshlrev_b32 v58, 16, v183
    v_and_b32 v59, 0xffff0000, v127
    v_and_b32 v60, 0xffff0000, v183
    v_add_f32 v57, v57, v58
    v_sub_f32 v59, v59, v60
    v_sub_f32 v251, v243, v57
    v_sub_f32 v255, v247, v59
    v_add_f32 v243, v243, v57
    v_add_f32 v247, v247, v59
    s_branch adaLN_cond__spectral_gfnet__glu_gated_bilinear__prompt_kernel_PQR36
adaLN_cond__spectral_gfnet__glu_gated_bilinear__prompt_kernel_FS37:
    s_nop 1
    ds_write2st64_b32 v26, v200, v201 offset0:0 offset1:1
    ds_write2st64_b32 v26, v202, v203 offset0:2 offset1:3
    ds_write2st64_b32 v26, v204, v205 offset0:16 offset1:17
    ds_write2st64_b32 v26, v206, v207 offset0:18 offset1:19
    ds_write2st64_b32 v26, v208, v209 offset0:33 offset1:34
    ds_write2st64_b32 v26, v210, v211 offset0:35 offset1:36
    ds_write2st64_b32 v26, v212, v213 offset0:49 offset1:50
    ds_write2st64_b32 v26, v214, v215 offset0:51 offset1:52
    s_cmp_lg_u32 s3, 0
    s_cbranch_scc1 adaLN_cond__spectral_gfnet__glu_gated_bilinear__prompt_kernel_RX40
    s_mov_b64 exec, 1
    ds_write_b32 v26, v200 offset:8192
    ds_write_b32 v26, v208 offset:16640
    s_mov_b64 exec, -1
adaLN_cond__spectral_gfnet__glu_gated_bilinear__prompt_kernel_RX40:
    s_waitcnt lgkmcnt(0)
    s_barrier
    ds_read2st64_b32 v[96:97], v63 offset0:19 offset1:18
    ds_read2st64_b32 v[98:99], v63 offset0:17 offset1:16
    ds_read2st64_b32 v[100:101], v63 offset0:3 offset1:2
    ds_read2st64_b32 v[102:103], v63 offset0:1 offset1:0
    ds_read2st64_b32 v[104:105], v63 offset0:52 offset1:51
    ds_read2st64_b32 v[106:107], v63 offset0:50 offset1:49
    ds_read2st64_b32 v[108:109], v63 offset0:36 offset1:35
    ds_read2st64_b32 v[110:111], v63 offset0:34 offset1:33
    s_waitcnt lgkmcnt(0)
    s_barrier
    v_mul_f32 v184, v200, v224
    v_mul_f32_e64 v188, -v200, v228
    v_mul_f32 v185, v201, v225
    v_mul_f32_e64 v189, -v201, v229
    v_mul_f32 v186, v202, v226
    v_mul_f32_e64 v190, -v202, v230
    v_mul_f32 v187, v203, v227
    v_mul_f32_e64 v191, -v203, v231
    v_fma_f32 v184, -v208, v228, v184
    v_fma_f32 v188, -v208, v224, v188
    v_fma_f32 v185, -v209, v229, v185
    v_fma_f32 v189, -v209, v225, v189
    v_fma_f32 v186, -v210, v230, v186
    v_fma_f32 v190, -v210, v226, v190
    v_fma_f32 v187, -v211, v231, v187
    v_fma_f32 v191, -v211, v227, v191
    v_fmac_f32 v184, v96, v232
    v_fma_f32 v188, -v96, v236, v188
    v_fmac_f32 v185, v97, v233
    v_fma_f32 v189, -v97, v237, v189
    v_fmac_f32 v186, v98, v234
    v_fma_f32 v190, -v98, v238, v190
    v_fmac_f32 v187, v99, v235
    v_fma_f32 v191, -v99, v239, v191
    v_fmac_f32 v184, v104, v236
    v_fmac_f32 v188, v104, v232
    v_fmac_f32 v185, v105, v237
    v_fmac_f32 v189, v105, v233
    v_fmac_f32 v186, v106, v238
    v_fmac_f32 v190, v106, v234
    v_fmac_f32 v187, v107, v239
    v_fmac_f32 v191, v107, v235
    v_cvt_pk_bf16_f32 v216, v184, v185
    v_cvt_pk_bf16_f32 v217, v186, v187
    v_cvt_pk_bf16_f32 v218, v188, v189
    v_cvt_pk_bf16_f32 v219, v190, v191
    v_mul_f32 v184, v204, v240
    v_mul_f32_e64 v188, -v204, v244
    v_mul_f32 v185, v205, v241
    v_mul_f32_e64 v189, -v205, v245
    v_mul_f32 v186, v206, v242
    v_mul_f32_e64 v190, -v206, v246
    v_mul_f32 v187, v207, v243
    v_mul_f32_e64 v191, -v207, v247
    v_fma_f32 v184, -v212, v244, v184
    v_fma_f32 v188, -v212, v240, v188
    v_fma_f32 v185, -v213, v245, v185
    v_fma_f32 v189, -v213, v241, v189
    v_fma_f32 v186, -v214, v246, v186
    v_fma_f32 v190, -v214, v242, v190
    v_fma_f32 v187, -v215, v247, v187
    v_fma_f32 v191, -v215, v243, v191
    v_fmac_f32 v184, v100, v248
    v_fma_f32 v188, -v100, v252, v188
    v_fmac_f32 v185, v101, v249
    v_fma_f32 v189, -v101, v253, v189
    v_fmac_f32 v186, v102, v250
    v_fma_f32 v190, -v102, v254, v190
    v_fmac_f32 v187, v103, v251
    v_fma_f32 v191, -v103, v255, v191
    v_fmac_f32 v184, v108, v252
    v_fmac_f32 v188, v108, v248
    v_fmac_f32 v185, v109, v253
    v_fmac_f32 v189, v109, v249
    v_fmac_f32 v186, v110, v254
    v_fmac_f32 v190, v110, v250
    v_fmac_f32 v187, v111, v255
    v_fmac_f32 v191, v111, v251
    v_cvt_pk_bf16_f32 v220, v184, v185
    v_cvt_pk_bf16_f32 v221, v186, v187
    v_cvt_pk_bf16_f32 v222, v188, v189
    v_cvt_pk_bf16_f32 v223, v190, v191
    v_mfma_f32_16x16x32_bf16 v[28:31], v[216:219], v[130:133], 0
    v_mfma_f32_16x16x32_bf16 v[176:179], v[216:219], v[128:131], 0
    v_mfma_f32_16x16x32_bf16 v[32:35], v[216:219], v[142:145], 0
    v_mfma_f32_16x16x32_bf16 v[180:183], v[216:219], v[140:143], 0
    s_branch adaLN_cond__spectral_gfnet__glu_gated_bilinear__prompt_kernel_FJ38
adaLN_cond__spectral_gfnet__glu_gated_bilinear__prompt_kernel_END1:
    s_endpgm
adaLN_cond__spectral_gfnet__glu_gated_bilinear__prompt_kernel_CEND:
.section .rodata,"a"
.p2align 6
.amdhsa_kernel adaLN_cond__spectral_gfnet__glu_gated_bilinear__prompt_kernel
  .amdhsa_next_free_vgpr 512
  .amdhsa_next_free_sgpr 68
  .amdhsa_accum_offset 256
  .amdhsa_group_segment_fixed_size 0
  .amdhsa_kernarg_size 96
  .amdhsa_user_sgpr_count 2
  .amdhsa_user_sgpr_kernarg_segment_ptr 1
  .amdhsa_system_sgpr_workgroup_id_x 1
.end_amdhsa_kernel
```
